```python
import torch

def _softmax(x, axis=-1):
    return torch.softmax(x, dim=axis)
def _gelu(x):
    return torch.nn.functional.gelu(x, approximate="tanh")
def _silu(x):
    return torch.nn.functional.silu(x)
def _sigmoid(x):
    return torch.sigmoid(x)
def _layernorm(x, axis=-1, eps=1e-5):
    m = x.mean(dim=axis, keepdim=True)
    v = x.var(dim=axis, keepdim=True, unbiased=False)
    return (x - m) / torch.sqrt(v + eps)
def _scatter_add(tgt, idx, src, axis=0):
    return tgt.clone().index_add_(axis, idx, src)
def _segment_sum(src, seg, n):
    out = torch.zeros((n,) + src.shape[1:], dtype=src.dtype)
    return out.index_add_(0, seg, src)
def _pad(x, pw):
    flat = tuple(v for pair in reversed(pw) for v in pair)
    return torch.nn.functional.pad(x, flat)

kernel_name = 'concat_heads__sliding_local_dilated__mha_block__prompt'

def setup_inputs():

    _w = (lambda a: (lambda t: t.to(torch.bfloat16) if t.is_floating_point() else t)(torch.as_tensor(a)))
    def _A_setup():
        B, S, D = 1, 2048, 640
        return {
            "x": _w((lambda *s: torch.randn(*s, dtype=torch.bfloat16) * 0.4)(B, S, D)),
            "wqkv": _w((lambda *s: torch.randn(*s, dtype=torch.bfloat16) * 0.4)(D, 3 * D)),
            "wo": _w((lambda *s: torch.randn(*s, dtype=torch.bfloat16) * 0.05)(D, D)),
        }
    _A_in = _A_setup()

    def _B_setup():
        B, S, D, H = 1, 2048, 640, 32
        return {
            "x": _w((lambda *s: torch.randn(*s, dtype=torch.bfloat16) * 0.2)(B, S, D)),
            "wqkv": _w((lambda *s: torch.randn(*s, dtype=torch.bfloat16) * 0.4)(D, 3 * D)),
            "wo": _w((lambda *s: torch.randn(*s, dtype=torch.bfloat16) * 0.1)(D, D)),
        }
    _B_in = _B_setup()

    return {
        "A_x": _A_in["x"],
        "A_wqkv": _A_in["wqkv"],
        "A_wo": _A_in["wo"],
        "B_x": _B_in["x"],
        "B_wqkv": _B_in["wqkv"],
        "B_wo": _B_in["wo"],
    }

def reference(A_x, A_wqkv, A_wo, B_x, B_wqkv, B_wo):
    def _A_ref(x, wqkv, wo):
        B, S, D = x.shape
        H = 32; Dh = D // H
        W, dil = 8, 2
        qkv = (lambda x, *d: x.permute(*d))((x @ wqkv).reshape(B, S, 3, H, Dh), 2, 0, 3, 1, 4)
        q, k, v = qkv[0], qkv[1], qkv[2]
        scale = Dh ** -0.5
        pos = torch.arange(S)
        off = torch.arange(W) * dil
        idx = pos[:, None] - off[None, :]
        mask = idx >= 0
        idx_c = torch.where(mask, idx, 0).reshape(-1)
        kg = k[:, :, idx_c, :].reshape(B, H, S, W, Dh)
        vg = v[:, :, idx_c, :].reshape(B, H, S, W, Dh)
        logits = torch.einsum("bhsd,bhswd->bhsw", q, kg) * scale
        logits = torch.where(mask[None, None, :, :], logits, -1e9)
        attn = _softmax(logits, axis=-1)
        o = torch.einsum("bhsw,bhswd->bhsd", attn, vg)
        return (lambda x, *d: x.permute(*d))(o, 0, 2, 1, 3).reshape(B, S, D) @ wo

    def _B_ref(x, wqkv, wo):
        B, S, D = x.shape
        H = 32
        Dh = D // H
        qkv = (lambda x, *d: x.permute(*d))((x @ wqkv).reshape(B, S, 3, H, Dh), 2, 0, 3, 1, 4)
        q, k, v = qkv[0], qkv[1], qkv[2]
        scores = torch.einsum("bhqd,bhkd->bhqk", q, k) * (Dh ** -0.5)
        p = _softmax(scores, axis=-1)
        o = torch.einsum("bhqk,bhkd->bhqd", p, v)
        return (lambda x, *d: x.permute(*d))(o, 0, 2, 1, 3).reshape(B, S, D) @ wo

    a = _A_ref(A_x, A_wqkv, A_wo)
    b = _B_ref(B_x, B_wqkv, B_wo)
    return torch.concatenate([a, b], axis=-1)
```

```asm
; @launch kernel=qkv_kernel grid=(240,1,1) block=(512,1,1) lds=147456
; @launch kernel=att_kernel grid=(256,1,1) block=(512,1,1) lds=73728
; @launch kernel=out_kernel grid=(256,1,1) block=(320,1,1) lds=143360
.amdgcn_target "amdgcn-amd-amdhsa--gfx950"
.text
.p2align 8
.globl qkv_kernel
.type qkv_kernel,@function
qkv_kernel:
    s_cmp_ge_u32 s2, 240
    s_cbranch_scc1 qkv_end
    s_load_dwordx16 s[4:19], s[0:1], 0
    s_load_dwordx2 s[20:21], s[0:1], 64
    s_and_b32 s26, s2, 7
    s_lshr_b32 s27, s2, 3
    s_lshr_b32 s22, s26, 2
    s_and_b32 s26, s26, 3
    s_lshl_b32 s26, s26, 1
    s_and_b32 s23, s27, 1
    s_add_u32 s23, s23, s26
    s_lshr_b32 s24, s27, 1
    v_lshrrev_b32 v1, 6, v0
    v_and_b32 v0, 63, v0
    v_readfirstlane_b32 s25, v1
    s_waitcnt lgkmcnt(0)
    s_lshr_b32 s54, s25, 1
    s_and_b32 s55, s25, 1
    s_lshl_b32 s52, s22, 24
    s_cmp_eq_u32 s22, 0
    s_cselect_b32 s28, s4, s10
    s_cselect_b32 s29, s5, s11
    s_cselect_b32 s32, s6, s12
    s_cselect_b32 s33, s7, s13
    s_add_u32 s36, s20, s52
    s_addc_u32 s37, s21, 0
    s_mov_b32 s30, 2621440
    s_mov_b32 s34, 2457600
    s_mov_b32 s38, 0x900000
    s_and_b32 s29, s29, 0xffff
    s_mov_b32 s31, 0x00020000
    s_and_b32 s33, s33, 0xffff
    s_mov_b32 s35, 0x00020000
    s_and_b32 s37, s37, 0xffff
    s_mov_b32 s39, 0x00020000
    v_lshrrev_b32 v4, 3, v0
    v_mul_u32_u24 v1, 1280, v4
    v_and_b32 v4, 7, v0
    v_lshrrev_b32 v5, 4, v0
    v_xor_b32 v4, v4, v5
    v_lshl_add_u32 v1, v4, 4, v1
    v_xor_b32 v2, 64, v1
    v_lshrrev_b32 v4, 2, v0
    v_mul_u32_u24 v3, 3840, v4
    v_and_b32 v4, 3, v0
    v_lshl_add_u32 v3, v4, 4, v3
    s_mul_i32 s52, s25, 4
    s_add_u32 s52, s52, 0
    s_lshl_b32 s46, s52, 10
    s_mul_i32 s53, s23, 32
    s_add_u32 s52, s52, s53
    s_mul_i32 s40, s52, 10240
    s_mul_i32 s52, s25, 4
    s_add_u32 s52, s52, 1
    s_lshl_b32 s47, s52, 10
    s_mul_i32 s53, s23, 32
    s_add_u32 s52, s52, s53
    s_mul_i32 s41, s52, 10240
    s_mul_i32 s52, s25, 4
    s_add_u32 s52, s52, 2
    s_lshl_b32 s48, s52, 10
    s_mul_i32 s53, s23, 32
    s_add_u32 s52, s52, s53
    s_mul_i32 s42, s52, 10240
    s_mul_i32 s52, s25, 4
    s_add_u32 s52, s52, 3
    s_lshl_b32 s49, s52, 10
    s_mul_i32 s53, s23, 32
    s_add_u32 s52, s52, s53
    s_mul_i32 s43, s52, 10240
    s_mul_i32 s52, s25, 2
    s_add_u32 s52, s52, 0
    s_lshl_b32 s50, s52, 10
    s_add_u32 s50, s50, 32768
    s_and_b32 s53, s52, 3
    s_mul_i32 s53, s53, 61440
    s_lshr_b32 s52, s52, 2
    s_lshl_b32 s52, s52, 6
    s_add_u32 s53, s53, s52
    s_mul_i32 s52, s24, 256
    s_add_u32 s44, s53, s52
    s_mul_i32 s52, s25, 2
    s_add_u32 s52, s52, 1
    s_lshl_b32 s51, s52, 10
    s_add_u32 s51, s51, 32768
    s_and_b32 s53, s52, 3
    s_mul_i32 s53, s53, 61440
    s_lshr_b32 s52, s52, 2
    s_lshl_b32 s52, s52, 6
    s_add_u32 s53, s53, s52
    s_mul_i32 s52, s24, 256
    s_add_u32 s45, s53, s52
    s_add_u32 s62, s24, s23
    s_cmp_ge_u32 s62, 10
    s_cselect_b32 s52, 10, 0
    s_sub_u32 s62, s62, s52
    s_cmp_ge_u32 s62, 10
    s_cselect_b32 s52, 10, 0
    s_sub_u32 s62, s62, s52
    s_cmp_ge_u32 s62, 10
    s_cselect_b32 s52, 10, 0
    s_sub_u32 s62, s62, s52
    s_cmp_ge_u32 s62, 10
    s_cselect_b32 s52, 10, 0
    s_sub_u32 s62, s62, s52
    s_lshl_b32 s52, s62, 7
    s_mul_i32 s53, s62, 245760
    s_add_u32 s40, s40, s52
    s_add_u32 s41, s41, s52
    s_add_u32 s42, s42, s52
    s_add_u32 s43, s43, s52
    s_add_u32 s44, s44, s53
    s_add_u32 s45, s45, s53
    s_add_u32 s62, s62, 1
    s_cmp_eq_u32 s62, 10
    s_cselect_b32 s63, 4294966016, 0
    s_cselect_b32 s64, 4292509696, 0
    s_cselect_b32 s62, 0, s62
    s_add_u32 s63, s63, 128
    s_add_u32 s64, s64, 245760
    s_add_u32 m0, s46, 0
    s_nop 0
    buffer_load_dwordx4 v1, s[28:31], s40 offen lds
    s_add_u32 s40, s40, s63
    s_add_u32 m0, s47, 0
    s_nop 0
    buffer_load_dwordx4 v2, s[28:31], s41 offen lds
    s_add_u32 s41, s41, s63
    s_add_u32 m0, s48, 0
    s_nop 0
    buffer_load_dwordx4 v1, s[28:31], s42 offen lds
    s_add_u32 s42, s42, s63
    s_add_u32 m0, s49, 0
    s_nop 0
    buffer_load_dwordx4 v2, s[28:31], s43 offen lds
    s_add_u32 s43, s43, s63
    s_add_u32 m0, s50, 0
    s_nop 0
    buffer_load_dwordx4 v3, s[32:35], s44 offen lds
    s_add_u32 s44, s44, s64
    s_add_u32 m0, s51, 0
    s_nop 0
    buffer_load_dwordx4 v3, s[32:35], s45 offen lds
    s_add_u32 s45, s45, s64
    v_and_b32 v4, 31, v0
    s_mul_i32 s52, s54, 64
    v_add_u32 v4, s52, v4
    v_lshlrev_b32 v4, 7, v4
    v_bfe_u32 v5, v0, 1, 3
    v_lshrrev_b32 v6, 5, v0
    v_add_u32 v7, 0, v6
    v_xor_b32 v7, v7, v5
    v_lshl_add_u32 v10, v7, 4, v4
    v_add_u32 v14, 49152, v10
    v_add_u32 v18, 98304, v10
    v_add_u32 v7, 2, v6
    v_xor_b32 v7, v7, v5
    v_lshl_add_u32 v11, v7, 4, v4
    v_add_u32 v15, 49152, v11
    v_add_u32 v19, 98304, v11
    v_add_u32 v7, 4, v6
    v_xor_b32 v7, v7, v5
    v_lshl_add_u32 v12, v7, 4, v4
    v_add_u32 v16, 49152, v12
    v_add_u32 v20, 98304, v12
    v_add_u32 v7, 6, v6
    v_xor_b32 v7, v7, v5
    v_lshl_add_u32 v13, v7, 4, v4
    v_add_u32 v17, 49152, v13
    v_add_u32 v21, 98304, v13
    v_bfe_u32 v4, v0, 2, 2
    v_lshl_add_u32 v5, v6, 3, v4
    v_lshlrev_b32 v5, 6, v5
    v_bfe_u32 v7, v0, 4, 1
    v_lshl_add_u32 v5, v7, 5, v5
    v_and_b32 v7, 3, v0
    v_lshl_add_u32 v5, v7, 3, v5
    s_mul_i32 s52, s55, 8192
    s_add_u32 s52, s52, 32768
    s_add_u32 s53, s52, 0
    v_add_u32 v22, s53, v5
    s_add_u32 s53, s52, 4096
    v_add_u32 v23, s53, v5
    s_add_u32 s53, s52, 49152
    v_add_u32 v24, s53, v5
    s_add_u32 s53, s52, 53248
    v_add_u32 v25, s53, v5
    s_add_u32 s53, s52, 98304
    v_add_u32 v26, s53, v5
    s_add_u32 s53, s52, 102400
    v_add_u32 v27, s53, v5
    v_mov_b32 v60, 0
    v_mov_b32 v61, 0
    v_mov_b32 v62, 0
    v_mov_b32 v63, 0
    v_mov_b32 v64, 0
    v_mov_b32 v65, 0
    v_mov_b32 v66, 0
    v_mov_b32 v67, 0
    v_mov_b32 v68, 0
    v_mov_b32 v69, 0
    v_mov_b32 v70, 0
    v_mov_b32 v71, 0
    v_mov_b32 v72, 0
    v_mov_b32 v73, 0
    v_mov_b32 v74, 0
    v_mov_b32 v75, 0
    v_mov_b32 v76, 0
    v_mov_b32 v77, 0
    v_mov_b32 v78, 0
    v_mov_b32 v79, 0
    v_mov_b32 v80, 0
    v_mov_b32 v81, 0
    v_mov_b32 v82, 0
    v_mov_b32 v83, 0
    v_mov_b32 v84, 0
    v_mov_b32 v85, 0
    v_mov_b32 v86, 0
    v_mov_b32 v87, 0
    v_mov_b32 v88, 0
    v_mov_b32 v89, 0
    v_mov_b32 v90, 0
    v_mov_b32 v91, 0
    v_mov_b32 v92, 0
    v_mov_b32 v93, 0
    v_mov_b32 v94, 0
    v_mov_b32 v95, 0
    v_mov_b32 v96, 0
    v_mov_b32 v97, 0
    v_mov_b32 v98, 0
    v_mov_b32 v99, 0
    v_mov_b32 v100, 0
    v_mov_b32 v101, 0
    v_mov_b32 v102, 0
    v_mov_b32 v103, 0
    v_mov_b32 v104, 0
    v_mov_b32 v105, 0
    v_mov_b32 v106, 0
    v_mov_b32 v107, 0
    v_mov_b32 v108, 0
    v_mov_b32 v109, 0
    v_mov_b32 v110, 0
    v_mov_b32 v111, 0
    v_mov_b32 v112, 0
    v_mov_b32 v113, 0
    v_mov_b32 v114, 0
    v_mov_b32 v115, 0
    v_mov_b32 v116, 0
    v_mov_b32 v117, 0
    v_mov_b32 v118, 0
    v_mov_b32 v119, 0
    v_mov_b32 v120, 0
    v_mov_b32 v121, 0
    v_mov_b32 v122, 0
    v_mov_b32 v123, 0
    s_add_u32 s62, s62, 1
    s_cmp_eq_u32 s62, 10
    s_cselect_b32 s63, 4294966016, 0
    s_cselect_b32 s64, 4292509696, 0
    s_cselect_b32 s62, 0, s62
    s_add_u32 s63, s63, 128
    s_add_u32 s64, s64, 245760
    s_add_u32 m0, s46, 49152
    s_nop 0
    buffer_load_dwordx4 v1, s[28:31], s40 offen lds
    s_add_u32 s40, s40, s63
    s_add_u32 m0, s47, 49152
    s_nop 0
    buffer_load_dwordx4 v2, s[28:31], s41 offen lds
    s_add_u32 s41, s41, s63
    s_add_u32 m0, s48, 49152
    s_nop 0
    buffer_load_dwordx4 v1, s[28:31], s42 offen lds
    s_add_u32 s42, s42, s63
    s_add_u32 m0, s49, 49152
    s_nop 0
    buffer_load_dwordx4 v2, s[28:31], s43 offen lds
    s_add_u32 s43, s43, s63
    s_add_u32 m0, s50, 49152
    s_nop 0
    buffer_load_dwordx4 v3, s[32:35], s44 offen lds
    s_add_u32 s44, s44, s64
    s_add_u32 m0, s51, 49152
    s_nop 0
    buffer_load_dwordx4 v3, s[32:35], s45 offen lds
    s_add_u32 s45, s45, s64
    s_cmp_ge_u32 s24, 10
    s_cbranch_scc1 qkv_vpath
    s_waitcnt vmcnt(6)
    s_barrier
    ds_read_b128 v[28:31], v10 offset:0
    ds_read_b128 v[32:35], v10 offset:4096
    ds_read_b64_tr_b16 v[44:45], v22 offset:0
    ds_read_b64_tr_b16 v[46:47], v22 offset:256
    ds_read_b64_tr_b16 v[48:49], v23 offset:0
    ds_read_b64_tr_b16 v[50:51], v23 offset:256
    ds_read_b128 v[36:39], v11 offset:0
    ds_read_b128 v[40:43], v11 offset:4096
    ds_read_b64_tr_b16 v[52:53], v22 offset:1024
    ds_read_b64_tr_b16 v[54:55], v22 offset:1280
    ds_read_b64_tr_b16 v[56:57], v23 offset:1024
    ds_read_b64_tr_b16 v[58:59], v23 offset:1280
    s_waitcnt lgkmcnt(6)
    v_mfma_f32_32x32x16_bf16 v[60:75], v[44:47], v[28:31], v[60:75]
    s_add_u32 s62, s62, 1
    s_cmp_eq_u32 s62, 10
    s_cselect_b32 s63, 4294966016, 0
    s_cselect_b32 s64, 4292509696, 0
    s_cselect_b32 s62, 0, s62
    s_add_u32 s63, s63, 128
    s_add_u32 s64, s64, 245760
    s_add_u32 m0, s46, 98304
    s_nop 0
    buffer_load_dwordx4 v1, s[28:31], s40 offen lds
    s_add_u32 s40, s40, s63
    v_mfma_f32_32x32x16_bf16 v[76:91], v[48:51], v[28:31], v[76:91]
    v_mfma_f32_32x32x16_bf16 v[92:107], v[44:47], v[32:35], v[92:107]
    s_add_u32 m0, s47, 98304
    s_nop 0
    buffer_load_dwordx4 v2, s[28:31], s41 offen lds
    s_add_u32 s41, s41, s63
    v_mfma_f32_32x32x16_bf16 v[108:123], v[48:51], v[32:35], v[108:123]
    ds_read_b128 v[28:31], v12 offset:0
    ds_read_b128 v[32:35], v12 offset:4096
    ds_read_b64_tr_b16 v[44:45], v22 offset:2048
    ds_read_b64_tr_b16 v[46:47], v22 offset:2304
    ds_read_b64_tr_b16 v[48:49], v23 offset:2048
    ds_read_b64_tr_b16 v[50:51], v23 offset:2304
    s_waitcnt lgkmcnt(6)
    v_mfma_f32_32x32x16_bf16 v[60:75], v[52:55], v[36:39], v[60:75]
    v_mfma_f32_32x32x16_bf16 v[76:91], v[56:59], v[36:39], v[76:91]
    s_add_u32 m0, s48, 98304
    s_nop 0
    buffer_load_dwordx4 v1, s[28:31], s42 offen lds
    s_add_u32 s42, s42, s63
    v_mfma_f32_32x32x16_bf16 v[92:107], v[52:55], v[40:43], v[92:107]
    v_mfma_f32_32x32x16_bf16 v[108:123], v[56:59], v[40:43], v[108:123]
    ds_read_b128 v[36:39], v13 offset:0
    ds_read_b128 v[40:43], v13 offset:4096
    ds_read_b64_tr_b16 v[52:53], v22 offset:3072
    ds_read_b64_tr_b16 v[54:55], v22 offset:3328
    ds_read_b64_tr_b16 v[56:57], v23 offset:3072
    ds_read_b64_tr_b16 v[58:59], v23 offset:3328
    s_waitcnt lgkmcnt(6)
    v_mfma_f32_32x32x16_bf16 v[60:75], v[44:47], v[28:31], v[60:75]
    s_add_u32 m0, s49, 98304
    s_nop 0
    buffer_load_dwordx4 v2, s[28:31], s43 offen lds
    s_add_u32 s43, s43, s63
    v_mfma_f32_32x32x16_bf16 v[76:91], v[48:51], v[28:31], v[76:91]
    v_mfma_f32_32x32x16_bf16 v[92:107], v[44:47], v[32:35], v[92:107]
    s_add_u32 m0, s50, 98304
    s_nop 0
    buffer_load_dwordx4 v3, s[32:35], s44 offen lds
    s_add_u32 s44, s44, s64
    v_mfma_f32_32x32x16_bf16 v[108:123], v[48:51], v[32:35], v[108:123]
    s_waitcnt lgkmcnt(0)
    v_mfma_f32_32x32x16_bf16 v[60:75], v[52:55], v[36:39], v[60:75]
    v_mfma_f32_32x32x16_bf16 v[76:91], v[56:59], v[36:39], v[76:91]
    s_add_u32 m0, s51, 98304
    s_nop 0
    buffer_load_dwordx4 v3, s[32:35], s45 offen lds
    s_add_u32 s45, s45, s64
    v_mfma_f32_32x32x16_bf16 v[92:107], v[52:55], v[40:43], v[92:107]
    v_mfma_f32_32x32x16_bf16 v[108:123], v[56:59], v[40:43], v[108:123]
    s_waitcnt vmcnt(6)
    s_barrier
    ds_read_b128 v[28:31], v14 offset:0
    ds_read_b128 v[32:35], v14 offset:4096
    ds_read_b64_tr_b16 v[44:45], v24 offset:0
    ds_read_b64_tr_b16 v[46:47], v24 offset:256
    ds_read_b64_tr_b16 v[48:49], v25 offset:0
    ds_read_b64_tr_b16 v[50:51], v25 offset:256
    ds_read_b128 v[36:39], v15 offset:0
    ds_read_b128 v[40:43], v15 offset:4096
    ds_read_b64_tr_b16 v[52:53], v24 offset:1024
    ds_read_b64_tr_b16 v[54:55], v24 offset:1280
    ds_read_b64_tr_b16 v[56:57], v25 offset:1024
    ds_read_b64_tr_b16 v[58:59], v25 offset:1280
    s_waitcnt lgkmcnt(6)
    v_mfma_f32_32x32x16_bf16 v[60:75], v[44:47], v[28:31], v[60:75]
    s_add_u32 s62, s62, 1
    s_cmp_eq_u32 s62, 10
    s_cselect_b32 s63, 4294966016, 0
    s_cselect_b32 s64, 4292509696, 0
    s_cselect_b32 s62, 0, s62
    s_add_u32 s63, s63, 128
    s_add_u32 s64, s64, 245760
    s_add_u32 m0, s46, 0
    s_nop 0
    buffer_load_dwordx4 v1, s[28:31], s40 offen lds
    s_add_u32 s40, s40, s63
    v_mfma_f32_32x32x16_bf16 v[76:91], v[48:51], v[28:31], v[76:91]
    v_mfma_f32_32x32x16_bf16 v[92:107], v[44:47], v[32:35], v[92:107]
    s_add_u32 m0, s47, 0
    s_nop 0
    buffer_load_dwordx4 v2, s[28:31], s41 offen lds
    s_add_u32 s41, s41, s63
    v_mfma_f32_32x32x16_bf16 v[108:123], v[48:51], v[32:35], v[108:123]
    ds_read_b128 v[28:31], v16 offset:0
    ds_read_b128 v[32:35], v16 offset:4096
    ds_read_b64_tr_b16 v[44:45], v24 offset:2048
    ds_read_b64_tr_b16 v[46:47], v24 offset:2304
    ds_read_b64_tr_b16 v[48:49], v25 offset:2048
    ds_read_b64_tr_b16 v[50:51], v25 offset:2304
    s_waitcnt lgkmcnt(6)
    v_mfma_f32_32x32x16_bf16 v[60:75], v[52:55], v[36:39], v[60:75]
    v_mfma_f32_32x32x16_bf16 v[76:91], v[56:59], v[36:39], v[76:91]
    s_add_u32 m0, s48, 0
    s_nop 0
    buffer_load_dwordx4 v1, s[28:31], s42 offen lds
    s_add_u32 s42, s42, s63
    v_mfma_f32_32x32x16_bf16 v[92:107], v[52:55], v[40:43], v[92:107]
    v_mfma_f32_32x32x16_bf16 v[108:123], v[56:59], v[40:43], v[108:123]
    ds_read_b128 v[36:39], v17 offset:0
    ds_read_b128 v[40:43], v17 offset:4096
    ds_read_b64_tr_b16 v[52:53], v24 offset:3072
    ds_read_b64_tr_b16 v[54:55], v24 offset:3328
    ds_read_b64_tr_b16 v[56:57], v25 offset:3072
    ds_read_b64_tr_b16 v[58:59], v25 offset:3328
    s_waitcnt lgkmcnt(6)
    v_mfma_f32_32x32x16_bf16 v[60:75], v[44:47], v[28:31], v[60:75]
    s_add_u32 m0, s49, 0
    s_nop 0
    buffer_load_dwordx4 v2, s[28:31], s43 offen lds
    s_add_u32 s43, s43, s63
    v_mfma_f32_32x32x16_bf16 v[76:91], v[48:51], v[28:31], v[76:91]
    v_mfma_f32_32x32x16_bf16 v[92:107], v[44:47], v[32:35], v[92:107]
    s_add_u32 m0, s50, 0
    s_nop 0
    buffer_load_dwordx4 v3, s[32:35], s44 offen lds
    s_add_u32 s44, s44, s64
    v_mfma_f32_32x32x16_bf16 v[108:123], v[48:51], v[32:35], v[108:123]
    s_waitcnt lgkmcnt(0)
    v_mfma_f32_32x32x16_bf16 v[60:75], v[52:55], v[36:39], v[60:75]
    v_mfma_f32_32x32x16_bf16 v[76:91], v[56:59], v[36:39], v[76:91]
    s_add_u32 m0, s51, 0
    s_nop 0
    buffer_load_dwordx4 v3, s[32:35], s45 offen lds
    s_add_u32 s45, s45, s64
    v_mfma_f32_32x32x16_bf16 v[92:107], v[52:55], v[40:43], v[92:107]
    v_mfma_f32_32x32x16_bf16 v[108:123], v[56:59], v[40:43], v[108:123]
    s_waitcnt vmcnt(6)
    s_barrier
    ds_read_b128 v[28:31], v18 offset:0
    ds_read_b128 v[32:35], v18 offset:4096
    ds_read_b64_tr_b16 v[44:45], v26 offset:0
    ds_read_b64_tr_b16 v[46:47], v26 offset:256
    ds_read_b64_tr_b16 v[48:49], v27 offset:0
    ds_read_b64_tr_b16 v[50:51], v27 offset:256
    ds_read_b128 v[36:39], v19 offset:0
    ds_read_b128 v[40:43], v19 offset:4096
    ds_read_b64_tr_b16 v[52:53], v26 offset:1024
    ds_read_b64_tr_b16 v[54:55], v26 offset:1280
    ds_read_b64_tr_b16 v[56:57], v27 offset:1024
    ds_read_b64_tr_b16 v[58:59], v27 offset:1280
    s_waitcnt lgkmcnt(6)
    v_mfma_f32_32x32x16_bf16 v[60:75], v[44:47], v[28:31], v[60:75]
    s_add_u32 s62, s62, 1
    s_cmp_eq_u32 s62, 10
    s_cselect_b32 s63, 4294966016, 0
    s_cselect_b32 s64, 4292509696, 0
    s_cselect_b32 s62, 0, s62
    s_add_u32 s63, s63, 128
    s_add_u32 s64, s64, 245760
    s_add_u32 m0, s46, 49152
    s_nop 0
    buffer_load_dwordx4 v1, s[28:31], s40 offen lds
    s_add_u32 s40, s40, s63
    v_mfma_f32_32x32x16_bf16 v[76:91], v[48:51], v[28:31], v[76:91]
    v_mfma_f32_32x32x16_bf16 v[92:107], v[44:47], v[32:35], v[92:107]
    s_add_u32 m0, s47, 49152
    s_nop 0
    buffer_load_dwordx4 v2, s[28:31], s41 offen lds
    s_add_u32 s41, s41, s63
    v_mfma_f32_32x32x16_bf16 v[108:123], v[48:51], v[32:35], v[108:123]
    ds_read_b128 v[28:31], v20 offset:0
    ds_read_b128 v[32:35], v20 offset:4096
    ds_read_b64_tr_b16 v[44:45], v26 offset:2048
    ds_read_b64_tr_b16 v[46:47], v26 offset:2304
    ds_read_b64_tr_b16 v[48:49], v27 offset:2048
    ds_read_b64_tr_b16 v[50:51], v27 offset:2304
    s_waitcnt lgkmcnt(6)
    v_mfma_f32_32x32x16_bf16 v[60:75], v[52:55], v[36:39], v[60:75]
    v_mfma_f32_32x32x16_bf16 v[76:91], v[56:59], v[36:39], v[76:91]
    s_add_u32 m0, s48, 49152
    s_nop 0
    buffer_load_dwordx4 v1, s[28:31], s42 offen lds
    s_add_u32 s42, s42, s63
    v_mfma_f32_32x32x16_bf16 v[92:107], v[52:55], v[40:43], v[92:107]
    v_mfma_f32_32x32x16_bf16 v[108:123], v[56:59], v[40:43], v[108:123]
    ds_read_b128 v[36:39], v21 offset:0
    ds_read_b128 v[40:43], v21 offset:4096
    ds_read_b64_tr_b16 v[52:53], v26 offset:3072
    ds_read_b64_tr_b16 v[54:55], v26 offset:3328
    ds_read_b64_tr_b16 v[56:57], v27 offset:3072
    ds_read_b64_tr_b16 v[58:59], v27 offset:3328
    s_waitcnt lgkmcnt(6)
    v_mfma_f32_32x32x16_bf16 v[60:75], v[44:47], v[28:31], v[60:75]
    s_add_u32 m0, s49, 49152
    s_nop 0
    buffer_load_dwordx4 v2, s[28:31], s43 offen lds
    s_add_u32 s43, s43, s63
    v_mfma_f32_32x32x16_bf16 v[76:91], v[48:51], v[28:31], v[76:91]
    v_mfma_f32_32x32x16_bf16 v[92:107], v[44:47], v[32:35], v[92:107]
    s_add_u32 m0, s50, 49152
    s_nop 0
    buffer_load_dwordx4 v3, s[32:35], s44 offen lds
    s_add_u32 s44, s44, s64
    v_mfma_f32_32x32x16_bf16 v[108:123], v[48:51], v[32:35], v[108:123]
    s_waitcnt lgkmcnt(0)
    v_mfma_f32_32x32x16_bf16 v[60:75], v[52:55], v[36:39], v[60:75]
    v_mfma_f32_32x32x16_bf16 v[76:91], v[56:59], v[36:39], v[76:91]
    s_add_u32 m0, s51, 49152
    s_nop 0
    buffer_load_dwordx4 v3, s[32:35], s45 offen lds
    s_add_u32 s45, s45, s64
    v_mfma_f32_32x32x16_bf16 v[92:107], v[52:55], v[40:43], v[92:107]
    v_mfma_f32_32x32x16_bf16 v[108:123], v[56:59], v[40:43], v[108:123]
    s_waitcnt vmcnt(6)
    s_barrier
    ds_read_b128 v[28:31], v10 offset:0
    ds_read_b128 v[32:35], v10 offset:4096
    ds_read_b64_tr_b16 v[44:45], v22 offset:0
    ds_read_b64_tr_b16 v[46:47], v22 offset:256
    ds_read_b64_tr_b16 v[48:49], v23 offset:0
    ds_read_b64_tr_b16 v[50:51], v23 offset:256
    ds_read_b128 v[36:39], v11 offset:0
    ds_read_b128 v[40:43], v11 offset:4096
    ds_read_b64_tr_b16 v[52:53], v22 offset:1024
    ds_read_b64_tr_b16 v[54:55], v22 offset:1280
    ds_read_b64_tr_b16 v[56:57], v23 offset:1024
    ds_read_b64_tr_b16 v[58:59], v23 offset:1280
    s_waitcnt lgkmcnt(6)
    v_mfma_f32_32x32x16_bf16 v[60:75], v[44:47], v[28:31], v[60:75]
    s_add_u32 s62, s62, 1
    s_cmp_eq_u32 s62, 10
    s_cselect_b32 s63, 4294966016, 0
    s_cselect_b32 s64, 4292509696, 0
    s_cselect_b32 s62, 0, s62
    s_add_u32 s63, s63, 128
    s_add_u32 s64, s64, 245760
    s_add_u32 m0, s46, 98304
    s_nop 0
    buffer_load_dwordx4 v1, s[28:31], s40 offen lds
    s_add_u32 s40, s40, s63
    v_mfma_f32_32x32x16_bf16 v[76:91], v[48:51], v[28:31], v[76:91]
    v_mfma_f32_32x32x16_bf16 v[92:107], v[44:47], v[32:35], v[92:107]
    s_add_u32 m0, s47, 98304
    s_nop 0
    buffer_load_dwordx4 v2, s[28:31], s41 offen lds
    s_add_u32 s41, s41, s63
    v_mfma_f32_32x32x16_bf16 v[108:123], v[48:51], v[32:35], v[108:123]
    ds_read_b128 v[28:31], v12 offset:0
    ds_read_b128 v[32:35], v12 offset:4096
    ds_read_b64_tr_b16 v[44:45], v22 offset:2048
    ds_read_b64_tr_b16 v[46:47], v22 offset:2304
    ds_read_b64_tr_b16 v[48:49], v23 offset:2048
    ds_read_b64_tr_b16 v[50:51], v23 offset:2304
    s_waitcnt lgkmcnt(6)
    v_mfma_f32_32x32x16_bf16 v[60:75], v[52:55], v[36:39], v[60:75]
    v_mfma_f32_32x32x16_bf16 v[76:91], v[56:59], v[36:39], v[76:91]
    s_add_u32 m0, s48, 98304
    s_nop 0
    buffer_load_dwordx4 v1, s[28:31], s42 offen lds
    s_add_u32 s42, s42, s63
    v_mfma_f32_32x32x16_bf16 v[92:107], v[52:55], v[40:43], v[92:107]
    v_mfma_f32_32x32x16_bf16 v[108:123], v[56:59], v[40:43], v[108:123]
    ds_read_b128 v[36:39], v13 offset:0
    ds_read_b128 v[40:43], v13 offset:4096
    ds_read_b64_tr_b16 v[52:53], v22 offset:3072
    ds_read_b64_tr_b16 v[54:55], v22 offset:3328
    ds_read_b64_tr_b16 v[56:57], v23 offset:3072
    ds_read_b64_tr_b16 v[58:59], v23 offset:3328
    s_waitcnt lgkmcnt(6)
    v_mfma_f32_32x32x16_bf16 v[60:75], v[44:47], v[28:31], v[60:75]
    s_add_u32 m0, s49, 98304
    s_nop 0
    buffer_load_dwordx4 v2, s[28:31], s43 offen lds
    s_add_u32 s43, s43, s63
    v_mfma_f32_32x32x16_bf16 v[76:91], v[48:51], v[28:31], v[76:91]
    v_mfma_f32_32x32x16_bf16 v[92:107], v[44:47], v[32:35], v[92:107]
    s_add_u32 m0, s50, 98304
    s_nop 0
    buffer_load_dwordx4 v3, s[32:35], s44 offen lds
    s_add_u32 s44, s44, s64
    v_mfma_f32_32x32x16_bf16 v[108:123], v[48:51], v[32:35], v[108:123]
    s_waitcnt lgkmcnt(0)
    v_mfma_f32_32x32x16_bf16 v[60:75], v[52:55], v[36:39], v[60:75]
    v_mfma_f32_32x32x16_bf16 v[76:91], v[56:59], v[36:39], v[76:91]
    s_add_u32 m0, s51, 98304
    s_nop 0
    buffer_load_dwordx4 v3, s[32:35], s45 offen lds
    s_add_u32 s45, s45, s64
    v_mfma_f32_32x32x16_bf16 v[92:107], v[52:55], v[40:43], v[92:107]
    v_mfma_f32_32x32x16_bf16 v[108:123], v[56:59], v[40:43], v[108:123]
    s_waitcnt vmcnt(6)
    s_barrier
    ds_read_b128 v[28:31], v14 offset:0
    ds_read_b128 v[32:35], v14 offset:4096
    ds_read_b64_tr_b16 v[44:45], v24 offset:0
    ds_read_b64_tr_b16 v[46:47], v24 offset:256
    ds_read_b64_tr_b16 v[48:49], v25 offset:0
    ds_read_b64_tr_b16 v[50:51], v25 offset:256
    ds_read_b128 v[36:39], v15 offset:0
    ds_read_b128 v[40:43], v15 offset:4096
    ds_read_b64_tr_b16 v[52:53], v24 offset:1024
    ds_read_b64_tr_b16 v[54:55], v24 offset:1280
    ds_read_b64_tr_b16 v[56:57], v25 offset:1024
    ds_read_b64_tr_b16 v[58:59], v25 offset:1280
    s_waitcnt lgkmcnt(6)
    v_mfma_f32_32x32x16_bf16 v[60:75], v[44:47], v[28:31], v[60:75]
    s_add_u32 s62, s62, 1
    s_cmp_eq_u32 s62, 10
    s_cselect_b32 s63, 4294966016, 0
    s_cselect_b32 s64, 4292509696, 0
    s_cselect_b32 s62, 0, s62
    s_add_u32 s63, s63, 128
    s_add_u32 s64, s64, 245760
    s_add_u32 m0, s46, 0
    s_nop 0
    buffer_load_dwordx4 v1, s[28:31], s40 offen lds
    s_add_u32 s40, s40, s63
    v_mfma_f32_32x32x16_bf16 v[76:91], v[48:51], v[28:31], v[76:91]
    v_mfma_f32_32x32x16_bf16 v[92:107], v[44:47], v[32:35], v[92:107]
    s_add_u32 m0, s47, 0
    s_nop 0
    buffer_load_dwordx4 v2, s[28:31], s41 offen lds
    s_add_u32 s41, s41, s63
    v_mfma_f32_32x32x16_bf16 v[108:123], v[48:51], v[32:35], v[108:123]
    ds_read_b128 v[28:31], v16 offset:0
    ds_read_b128 v[32:35], v16 offset:4096
    ds_read_b64_tr_b16 v[44:45], v24 offset:2048
    ds_read_b64_tr_b16 v[46:47], v24 offset:2304
    ds_read_b64_tr_b16 v[48:49], v25 offset:2048
    ds_read_b64_tr_b16 v[50:51], v25 offset:2304
    s_waitcnt lgkmcnt(6)
    v_mfma_f32_32x32x16_bf16 v[60:75], v[52:55], v[36:39], v[60:75]
    v_mfma_f32_32x32x16_bf16 v[76:91], v[56:59], v[36:39], v[76:91]
    s_add_u32 m0, s48, 0
    s_nop 0
    buffer_load_dwordx4 v1, s[28:31], s42 offen lds
    s_add_u32 s42, s42, s63
    v_mfma_f32_32x32x16_bf16 v[92:107], v[52:55], v[40:43], v[92:107]
    v_mfma_f32_32x32x16_bf16 v[108:123], v[56:59], v[40:43], v[108:123]
    ds_read_b128 v[36:39], v17 offset:0
    ds_read_b128 v[40:43], v17 offset:4096
    ds_read_b64_tr_b16 v[52:53], v24 offset:3072
    ds_read_b64_tr_b16 v[54:55], v24 offset:3328
    ds_read_b64_tr_b16 v[56:57], v25 offset:3072
    ds_read_b64_tr_b16 v[58:59], v25 offset:3328
    s_waitcnt lgkmcnt(6)
    v_mfma_f32_32x32x16_bf16 v[60:75], v[44:47], v[28:31], v[60:75]
    s_add_u32 m0, s49, 0
    s_nop 0
    buffer_load_dwordx4 v2, s[28:31], s43 offen lds
    s_add_u32 s43, s43, s63
    v_mfma_f32_32x32x16_bf16 v[76:91], v[48:51], v[28:31], v[76:91]
    v_mfma_f32_32x32x16_bf16 v[92:107], v[44:47], v[32:35], v[92:107]
    s_add_u32 m0, s50, 0
    s_nop 0
    buffer_load_dwordx4 v3, s[32:35], s44 offen lds
    s_add_u32 s44, s44, s64
    v_mfma_f32_32x32x16_bf16 v[108:123], v[48:51], v[32:35], v[108:123]
    s_waitcnt lgkmcnt(0)
    v_mfma_f32_32x32x16_bf16 v[60:75], v[52:55], v[36:39], v[60:75]
    v_mfma_f32_32x32x16_bf16 v[76:91], v[56:59], v[36:39], v[76:91]
    s_add_u32 m0, s51, 0
    s_nop 0
    buffer_load_dwordx4 v3, s[32:35], s45 offen lds
    s_add_u32 s45, s45, s64
    v_mfma_f32_32x32x16_bf16 v[92:107], v[52:55], v[40:43], v[92:107]
    v_mfma_f32_32x32x16_bf16 v[108:123], v[56:59], v[40:43], v[108:123]
    s_waitcnt vmcnt(6)
    s_barrier
    ds_read_b128 v[28:31], v18 offset:0
    ds_read_b128 v[32:35], v18 offset:4096
    ds_read_b64_tr_b16 v[44:45], v26 offset:0
    ds_read_b64_tr_b16 v[46:47], v26 offset:256
    ds_read_b64_tr_b16 v[48:49], v27 offset:0
    ds_read_b64_tr_b16 v[50:51], v27 offset:256
    ds_read_b128 v[36:39], v19 offset:0
    ds_read_b128 v[40:43], v19 offset:4096
    ds_read_b64_tr_b16 v[52:53], v26 offset:1024
    ds_read_b64_tr_b16 v[54:55], v26 offset:1280
    ds_read_b64_tr_b16 v[56:57], v27 offset:1024
    ds_read_b64_tr_b16 v[58:59], v27 offset:1280
    s_waitcnt lgkmcnt(6)
    v_mfma_f32_32x32x16_bf16 v[60:75], v[44:47], v[28:31], v[60:75]
    s_add_u32 s62, s62, 1
    s_cmp_eq_u32 s62, 10
    s_cselect_b32 s63, 4294966016, 0
    s_cselect_b32 s64, 4292509696, 0
    s_cselect_b32 s62, 0, s62
    s_add_u32 s63, s63, 128
    s_add_u32 s64, s64, 245760
    s_add_u32 m0, s46, 49152
    s_nop 0
    buffer_load_dwordx4 v1, s[28:31], s40 offen lds
    s_add_u32 s40, s40, s63
    v_mfma_f32_32x32x16_bf16 v[76:91], v[48:51], v[28:31], v[76:91]
    v_mfma_f32_32x32x16_bf16 v[92:107], v[44:47], v[32:35], v[92:107]
    s_add_u32 m0, s47, 49152
    s_nop 0
    buffer_load_dwordx4 v2, s[28:31], s41 offen lds
    s_add_u32 s41, s41, s63
    v_mfma_f32_32x32x16_bf16 v[108:123], v[48:51], v[32:35], v[108:123]
    ds_read_b128 v[28:31], v20 offset:0
    ds_read_b128 v[32:35], v20 offset:4096
    ds_read_b64_tr_b16 v[44:45], v26 offset:2048
    ds_read_b64_tr_b16 v[46:47], v26 offset:2304
    ds_read_b64_tr_b16 v[48:49], v27 offset:2048
    ds_read_b64_tr_b16 v[50:51], v27 offset:2304
    s_waitcnt lgkmcnt(6)
    v_mfma_f32_32x32x16_bf16 v[60:75], v[52:55], v[36:39], v[60:75]
    v_mfma_f32_32x32x16_bf16 v[76:91], v[56:59], v[36:39], v[76:91]
    s_add_u32 m0, s48, 49152
    s_nop 0
    buffer_load_dwordx4 v1, s[28:31], s42 offen lds
    s_add_u32 s42, s42, s63
    v_mfma_f32_32x32x16_bf16 v[92:107], v[52:55], v[40:43], v[92:107]
    v_mfma_f32_32x32x16_bf16 v[108:123], v[56:59], v[40:43], v[108:123]
    ds_read_b128 v[36:39], v21 offset:0
    ds_read_b128 v[40:43], v21 offset:4096
    ds_read_b64_tr_b16 v[52:53], v26 offset:3072
    ds_read_b64_tr_b16 v[54:55], v26 offset:3328
    ds_read_b64_tr_b16 v[56:57], v27 offset:3072
    ds_read_b64_tr_b16 v[58:59], v27 offset:3328
    s_waitcnt lgkmcnt(6)
    v_mfma_f32_32x32x16_bf16 v[60:75], v[44:47], v[28:31], v[60:75]
    s_add_u32 m0, s49, 49152
    s_nop 0
    buffer_load_dwordx4 v2, s[28:31], s43 offen lds
    s_add_u32 s43, s43, s63
    v_mfma_f32_32x32x16_bf16 v[76:91], v[48:51], v[28:31], v[76:91]
    v_mfma_f32_32x32x16_bf16 v[92:107], v[44:47], v[32:35], v[92:107]
    s_add_u32 m0, s50, 49152
    s_nop 0
    buffer_load_dwordx4 v3, s[32:35], s44 offen lds
    s_add_u32 s44, s44, s64
    v_mfma_f32_32x32x16_bf16 v[108:123], v[48:51], v[32:35], v[108:123]
    s_waitcnt lgkmcnt(0)
    v_mfma_f32_32x32x16_bf16 v[60:75], v[52:55], v[36:39], v[60:75]
    v_mfma_f32_32x32x16_bf16 v[76:91], v[56:59], v[36:39], v[76:91]
    s_add_u32 m0, s51, 49152
    s_nop 0
    buffer_load_dwordx4 v3, s[32:35], s45 offen lds
    s_add_u32 s45, s45, s64
    v_mfma_f32_32x32x16_bf16 v[92:107], v[52:55], v[40:43], v[92:107]
    v_mfma_f32_32x32x16_bf16 v[108:123], v[56:59], v[40:43], v[108:123]
    s_waitcnt vmcnt(6)
    s_barrier
    ds_read_b128 v[28:31], v10 offset:0
    ds_read_b128 v[32:35], v10 offset:4096
    ds_read_b64_tr_b16 v[44:45], v22 offset:0
    ds_read_b64_tr_b16 v[46:47], v22 offset:256
    ds_read_b64_tr_b16 v[48:49], v23 offset:0
    ds_read_b64_tr_b16 v[50:51], v23 offset:256
    ds_read_b128 v[36:39], v11 offset:0
    ds_read_b128 v[40:43], v11 offset:4096
    ds_read_b64_tr_b16 v[52:53], v22 offset:1024
    ds_read_b64_tr_b16 v[54:55], v22 offset:1280
    ds_read_b64_tr_b16 v[56:57], v23 offset:1024
    ds_read_b64_tr_b16 v[58:59], v23 offset:1280
    s_waitcnt lgkmcnt(6)
    v_mfma_f32_32x32x16_bf16 v[60:75], v[44:47], v[28:31], v[60:75]
    s_add_u32 s62, s62, 1
    s_cmp_eq_u32 s62, 10
    s_cselect_b32 s63, 4294966016, 0
    s_cselect_b32 s64, 4292509696, 0
    s_cselect_b32 s62, 0, s62
    s_add_u32 s63, s63, 128
    s_add_u32 s64, s64, 245760
    s_add_u32 m0, s46, 98304
    s_nop 0
    buffer_load_dwordx4 v1, s[28:31], s40 offen lds
    s_add_u32 s40, s40, s63
    v_mfma_f32_32x32x16_bf16 v[76:91], v[48:51], v[28:31], v[76:91]
    v_mfma_f32_32x32x16_bf16 v[92:107], v[44:47], v[32:35], v[92:107]
    s_add_u32 m0, s47, 98304
    s_nop 0
    buffer_load_dwordx4 v2, s[28:31], s41 offen lds
    s_add_u32 s41, s41, s63
    v_mfma_f32_32x32x16_bf16 v[108:123], v[48:51], v[32:35], v[108:123]
    ds_read_b128 v[28:31], v12 offset:0
    ds_read_b128 v[32:35], v12 offset:4096
    ds_read_b64_tr_b16 v[44:45], v22 offset:2048
    ds_read_b64_tr_b16 v[46:47], v22 offset:2304
    ds_read_b64_tr_b16 v[48:49], v23 offset:2048
    ds_read_b64_tr_b16 v[50:51], v23 offset:2304
    s_waitcnt lgkmcnt(6)
    v_mfma_f32_32x32x16_bf16 v[60:75], v[52:55], v[36:39], v[60:75]
    v_mfma_f32_32x32x16_bf16 v[76:91], v[56:59], v[36:39], v[76:91]
    s_add_u32 m0, s48, 98304
    s_nop 0
    buffer_load_dwordx4 v1, s[28:31], s42 offen lds
    s_add_u32 s42, s42, s63
    v_mfma_f32_32x32x16_bf16 v[92:107], v[52:55], v[40:43], v[92:107]
    v_mfma_f32_32x32x16_bf16 v[108:123], v[56:59], v[40:43], v[108:123]
    ds_read_b128 v[36:39], v13 offset:0
    ds_read_b128 v[40:43], v13 offset:4096
    ds_read_b64_tr_b16 v[52:53], v22 offset:3072
    ds_read_b64_tr_b16 v[54:55], v22 offset:3328
    ds_read_b64_tr_b16 v[56:57], v23 offset:3072
    ds_read_b64_tr_b16 v[58:59], v23 offset:3328
    s_waitcnt lgkmcnt(6)
    v_mfma_f32_32x32x16_bf16 v[60:75], v[44:47], v[28:31], v[60:75]
    s_add_u32 m0, s49, 98304
    s_nop 0
    buffer_load_dwordx4 v2, s[28:31], s43 offen lds
    s_add_u32 s43, s43, s63
    v_mfma_f32_32x32x16_bf16 v[76:91], v[48:51], v[28:31], v[76:91]
    v_mfma_f32_32x32x16_bf16 v[92:107], v[44:47], v[32:35], v[92:107]
    s_add_u32 m0, s50, 98304
    s_nop 0
    buffer_load_dwordx4 v3, s[32:35], s44 offen lds
    s_add_u32 s44, s44, s64
    v_mfma_f32_32x32x16_bf16 v[108:123], v[48:51], v[32:35], v[108:123]
    s_waitcnt lgkmcnt(0)
    v_mfma_f32_32x32x16_bf16 v[60:75], v[52:55], v[36:39], v[60:75]
    v_mfma_f32_32x32x16_bf16 v[76:91], v[56:59], v[36:39], v[76:91]
    s_add_u32 m0, s51, 98304
    s_nop 0
    buffer_load_dwordx4 v3, s[32:35], s45 offen lds
    s_add_u32 s45, s45, s64
    v_mfma_f32_32x32x16_bf16 v[92:107], v[52:55], v[40:43], v[92:107]
    v_mfma_f32_32x32x16_bf16 v[108:123], v[56:59], v[40:43], v[108:123]
    s_waitcnt vmcnt(6)
    s_barrier
    ds_read_b128 v[28:31], v14 offset:0
    ds_read_b128 v[32:35], v14 offset:4096
    ds_read_b64_tr_b16 v[44:45], v24 offset:0
    ds_read_b64_tr_b16 v[46:47], v24 offset:256
    ds_read_b64_tr_b16 v[48:49], v25 offset:0
    ds_read_b64_tr_b16 v[50:51], v25 offset:256
    ds_read_b128 v[36:39], v15 offset:0
    ds_read_b128 v[40:43], v15 offset:4096
    ds_read_b64_tr_b16 v[52:53], v24 offset:1024
    ds_read_b64_tr_b16 v[54:55], v24 offset:1280
    ds_read_b64_tr_b16 v[56:57], v25 offset:1024
    ds_read_b64_tr_b16 v[58:59], v25 offset:1280
    s_waitcnt lgkmcnt(6)
    v_mfma_f32_32x32x16_bf16 v[60:75], v[44:47], v[28:31], v[60:75]
    s_add_u32 s62, s62, 1
    s_cmp_eq_u32 s62, 10
    s_cselect_b32 s63, 4294966016, 0
    s_cselect_b32 s64, 4292509696, 0
    s_cselect_b32 s62, 0, s62
    s_add_u32 s63, s63, 128
    s_add_u32 s64, s64, 245760
    s_add_u32 m0, s46, 0
    s_nop 0
    buffer_load_dwordx4 v1, s[28:31], s40 offen lds
    s_add_u32 s40, s40, s63
    v_mfma_f32_32x32x16_bf16 v[76:91], v[48:51], v[28:31], v[76:91]
    v_mfma_f32_32x32x16_bf16 v[92:107], v[44:47], v[32:35], v[92:107]
    s_add_u32 m0, s47, 0
    s_nop 0
    buffer_load_dwordx4 v2, s[28:31], s41 offen lds
    s_add_u32 s41, s41, s63
    v_mfma_f32_32x32x16_bf16 v[108:123], v[48:51], v[32:35], v[108:123]
    ds_read_b128 v[28:31], v16 offset:0
    ds_read_b128 v[32:35], v16 offset:4096
    ds_read_b64_tr_b16 v[44:45], v24 offset:2048
    ds_read_b64_tr_b16 v[46:47], v24 offset:2304
    ds_read_b64_tr_b16 v[48:49], v25 offset:2048
    ds_read_b64_tr_b16 v[50:51], v25 offset:2304
    s_waitcnt lgkmcnt(6)
    v_mfma_f32_32x32x16_bf16 v[60:75], v[52:55], v[36:39], v[60:75]
    v_mfma_f32_32x32x16_bf16 v[76:91], v[56:59], v[36:39], v[76:91]
    s_add_u32 m0, s48, 0
    s_nop 0
    buffer_load_dwordx4 v1, s[28:31], s42 offen lds
    s_add_u32 s42, s42, s63
    v_mfma_f32_32x32x16_bf16 v[92:107], v[52:55], v[40:43], v[92:107]
    v_mfma_f32_32x32x16_bf16 v[108:123], v[56:59], v[40:43], v[108:123]
    ds_read_b128 v[36:39], v17 offset:0
    ds_read_b128 v[40:43], v17 offset:4096
    ds_read_b64_tr_b16 v[52:53], v24 offset:3072
    ds_read_b64_tr_b16 v[54:55], v24 offset:3328
    ds_read_b64_tr_b16 v[56:57], v25 offset:3072
    ds_read_b64_tr_b16 v[58:59], v25 offset:3328
    s_waitcnt lgkmcnt(6)
    v_mfma_f32_32x32x16_bf16 v[60:75], v[44:47], v[28:31], v[60:75]
    s_add_u32 m0, s49, 0
    s_nop 0
    buffer_load_dwordx4 v2, s[28:31], s43 offen lds
    s_add_u32 s43, s43, s63
    v_mfma_f32_32x32x16_bf16 v[76:91], v[48:51], v[28:31], v[76:91]
    v_mfma_f32_32x32x16_bf16 v[92:107], v[44:47], v[32:35], v[92:107]
    s_add_u32 m0, s50, 0
    s_nop 0
    buffer_load_dwordx4 v3, s[32:35], s44 offen lds
    s_add_u32 s44, s44, s64
    v_mfma_f32_32x32x16_bf16 v[108:123], v[48:51], v[32:35], v[108:123]
    s_waitcnt lgkmcnt(0)
    v_mfma_f32_32x32x16_bf16 v[60:75], v[52:55], v[36:39], v[60:75]
    v_mfma_f32_32x32x16_bf16 v[76:91], v[56:59], v[36:39], v[76:91]
    s_add_u32 m0, s51, 0
    s_nop 0
    buffer_load_dwordx4 v3, s[32:35], s45 offen lds
    s_add_u32 s45, s45, s64
    v_mfma_f32_32x32x16_bf16 v[92:107], v[52:55], v[40:43], v[92:107]
    v_mfma_f32_32x32x16_bf16 v[108:123], v[56:59], v[40:43], v[108:123]
    s_waitcnt vmcnt(6)
    s_barrier
    ds_read_b128 v[28:31], v18 offset:0
    ds_read_b128 v[32:35], v18 offset:4096
    ds_read_b64_tr_b16 v[44:45], v26 offset:0
    ds_read_b64_tr_b16 v[46:47], v26 offset:256
    ds_read_b64_tr_b16 v[48:49], v27 offset:0
    ds_read_b64_tr_b16 v[50:51], v27 offset:256
    ds_read_b128 v[36:39], v19 offset:0
    ds_read_b128 v[40:43], v19 offset:4096
    ds_read_b64_tr_b16 v[52:53], v26 offset:1024
    ds_read_b64_tr_b16 v[54:55], v26 offset:1280
    ds_read_b64_tr_b16 v[56:57], v27 offset:1024
    ds_read_b64_tr_b16 v[58:59], v27 offset:1280
    s_waitcnt lgkmcnt(6)
    v_mfma_f32_32x32x16_bf16 v[60:75], v[44:47], v[28:31], v[60:75]
    v_mfma_f32_32x32x16_bf16 v[76:91], v[48:51], v[28:31], v[76:91]
    v_mfma_f32_32x32x16_bf16 v[92:107], v[44:47], v[32:35], v[92:107]
    v_mfma_f32_32x32x16_bf16 v[108:123], v[48:51], v[32:35], v[108:123]
    ds_read_b128 v[28:31], v20 offset:0
    ds_read_b128 v[32:35], v20 offset:4096
    ds_read_b64_tr_b16 v[44:45], v26 offset:2048
    ds_read_b64_tr_b16 v[46:47], v26 offset:2304
    ds_read_b64_tr_b16 v[48:49], v27 offset:2048
    ds_read_b64_tr_b16 v[50:51], v27 offset:2304
    s_waitcnt lgkmcnt(6)
    v_mfma_f32_32x32x16_bf16 v[60:75], v[52:55], v[36:39], v[60:75]
    v_mfma_f32_32x32x16_bf16 v[76:91], v[56:59], v[36:39], v[76:91]
    v_mfma_f32_32x32x16_bf16 v[92:107], v[52:55], v[40:43], v[92:107]
    v_mfma_f32_32x32x16_bf16 v[108:123], v[56:59], v[40:43], v[108:123]
    ds_read_b128 v[36:39], v21 offset:0
    ds_read_b128 v[40:43], v21 offset:4096
    ds_read_b64_tr_b16 v[52:53], v26 offset:3072
    ds_read_b64_tr_b16 v[54:55], v26 offset:3328
    ds_read_b64_tr_b16 v[56:57], v27 offset:3072
    ds_read_b64_tr_b16 v[58:59], v27 offset:3328
    s_waitcnt lgkmcnt(6)
    v_mfma_f32_32x32x16_bf16 v[60:75], v[44:47], v[28:31], v[60:75]
    v_mfma_f32_32x32x16_bf16 v[76:91], v[48:51], v[28:31], v[76:91]
    v_mfma_f32_32x32x16_bf16 v[92:107], v[44:47], v[32:35], v[92:107]
    v_mfma_f32_32x32x16_bf16 v[108:123], v[48:51], v[32:35], v[108:123]
    s_waitcnt lgkmcnt(0)
    v_mfma_f32_32x32x16_bf16 v[60:75], v[52:55], v[36:39], v[60:75]
    v_mfma_f32_32x32x16_bf16 v[76:91], v[56:59], v[36:39], v[76:91]
    v_mfma_f32_32x32x16_bf16 v[92:107], v[52:55], v[40:43], v[92:107]
    v_mfma_f32_32x32x16_bf16 v[108:123], v[56:59], v[40:43], v[108:123]
    s_waitcnt vmcnt(0)
    s_barrier
    ds_read_b128 v[28:31], v10 offset:0
    ds_read_b128 v[32:35], v10 offset:4096
    ds_read_b64_tr_b16 v[44:45], v22 offset:0
    ds_read_b64_tr_b16 v[46:47], v22 offset:256
    ds_read_b64_tr_b16 v[48:49], v23 offset:0
    ds_read_b64_tr_b16 v[50:51], v23 offset:256
    ds_read_b128 v[36:39], v11 offset:0
    ds_read_b128 v[40:43], v11 offset:4096
    ds_read_b64_tr_b16 v[52:53], v22 offset:1024
    ds_read_b64_tr_b16 v[54:55], v22 offset:1280
    ds_read_b64_tr_b16 v[56:57], v23 offset:1024
    ds_read_b64_tr_b16 v[58:59], v23 offset:1280
    s_waitcnt lgkmcnt(6)
    v_mfma_f32_32x32x16_bf16 v[60:75], v[44:47], v[28:31], v[60:75]
    v_mfma_f32_32x32x16_bf16 v[76:91], v[48:51], v[28:31], v[76:91]
    v_mfma_f32_32x32x16_bf16 v[92:107], v[44:47], v[32:35], v[92:107]
    v_mfma_f32_32x32x16_bf16 v[108:123], v[48:51], v[32:35], v[108:123]
    ds_read_b128 v[28:31], v12 offset:0
    ds_read_b128 v[32:35], v12 offset:4096
    ds_read_b64_tr_b16 v[44:45], v22 offset:2048
    ds_read_b64_tr_b16 v[46:47], v22 offset:2304
    ds_read_b64_tr_b16 v[48:49], v23 offset:2048
    ds_read_b64_tr_b16 v[50:51], v23 offset:2304
    s_waitcnt lgkmcnt(6)
    v_mfma_f32_32x32x16_bf16 v[60:75], v[52:55], v[36:39], v[60:75]
    v_mfma_f32_32x32x16_bf16 v[76:91], v[56:59], v[36:39], v[76:91]
    v_mfma_f32_32x32x16_bf16 v[92:107], v[52:55], v[40:43], v[92:107]
    v_mfma_f32_32x32x16_bf16 v[108:123], v[56:59], v[40:43], v[108:123]
    ds_read_b128 v[36:39], v13 offset:0
    ds_read_b128 v[40:43], v13 offset:4096
    ds_read_b64_tr_b16 v[52:53], v22 offset:3072
    ds_read_b64_tr_b16 v[54:55], v22 offset:3328
    ds_read_b64_tr_b16 v[56:57], v23 offset:3072
    ds_read_b64_tr_b16 v[58:59], v23 offset:3328
    s_waitcnt lgkmcnt(6)
    v_mfma_f32_32x32x16_bf16 v[60:75], v[44:47], v[28:31], v[60:75]
    v_mfma_f32_32x32x16_bf16 v[76:91], v[48:51], v[28:31], v[76:91]
    v_mfma_f32_32x32x16_bf16 v[92:107], v[44:47], v[32:35], v[92:107]
    v_mfma_f32_32x32x16_bf16 v[108:123], v[48:51], v[32:35], v[108:123]
    s_waitcnt lgkmcnt(0)
    v_mfma_f32_32x32x16_bf16 v[60:75], v[52:55], v[36:39], v[60:75]
    v_mfma_f32_32x32x16_bf16 v[76:91], v[56:59], v[36:39], v[76:91]
    v_mfma_f32_32x32x16_bf16 v[92:107], v[52:55], v[40:43], v[92:107]
    v_mfma_f32_32x32x16_bf16 v[108:123], v[56:59], v[40:43], v[108:123]
    s_nop 15
    s_cmp_ge_u32 s24, 5
    s_cselect_b32 s52, 5, 0
    s_cselect_b32 s56, 3145728, 0
    s_cselect_b32 s57, 1.0, 0x3ea52b5c
    s_sub_u32 s52, s24, s52
    s_lshl_b32 s52, s52, 7
    s_lshl_b32 s53, s55, 6
    s_add_u32 s52, s52, s53
    s_mul_i32 s53, s23, 4
    s_add_u32 s53, s53, s54
    s_mul_i32 s53, s53, 3072
    s_add_u32 s56, s56, s53
    v_mul_f32 v60, s57, v60
    v_mul_f32 v61, s57, v61
    v_mul_f32 v62, s57, v62
    v_mul_f32 v63, s57, v63
    v_mul_f32 v64, s57, v64
    v_mul_f32 v65, s57, v65
    v_mul_f32 v66, s57, v66
    v_mul_f32 v67, s57, v67
    v_mul_f32 v68, s57, v68
    v_mul_f32 v69, s57, v69
    v_mul_f32 v70, s57, v70
    v_mul_f32 v71, s57, v71
    v_mul_f32 v72, s57, v72
    v_mul_f32 v73, s57, v73
    v_mul_f32 v74, s57, v74
    v_mul_f32 v75, s57, v75
    v_mul_f32 v76, s57, v76
    v_mul_f32 v77, s57, v77
    v_mul_f32 v78, s57, v78
    v_mul_f32 v79, s57, v79
    v_mul_f32 v80, s57, v80
    v_mul_f32 v81, s57, v81
    v_mul_f32 v82, s57, v82
    v_mul_f32 v83, s57, v83
    v_mul_f32 v84, s57, v84
    v_mul_f32 v85, s57, v85
    v_mul_f32 v86, s57, v86
    v_mul_f32 v87, s57, v87
    v_mul_f32 v88, s57, v88
    v_mul_f32 v89, s57, v89
    v_mul_f32 v90, s57, v90
    v_mul_f32 v91, s57, v91
    v_mul_f32 v92, s57, v92
    v_mul_f32 v93, s57, v93
    v_mul_f32 v94, s57, v94
    v_mul_f32 v95, s57, v95
    v_mul_f32 v96, s57, v96
    v_mul_f32 v97, s57, v97
    v_mul_f32 v98, s57, v98
    v_mul_f32 v99, s57, v99
    v_mul_f32 v100, s57, v100
    v_mul_f32 v101, s57, v101
    v_mul_f32 v102, s57, v102
    v_mul_f32 v103, s57, v103
    v_mul_f32 v104, s57, v104
    v_mul_f32 v105, s57, v105
    v_mul_f32 v106, s57, v106
    v_mul_f32 v107, s57, v107
    v_mul_f32 v108, s57, v108
    v_mul_f32 v109, s57, v109
    v_mul_f32 v110, s57, v110
    v_mul_f32 v111, s57, v111
    v_mul_f32 v112, s57, v112
    v_mul_f32 v113, s57, v113
    v_mul_f32 v114, s57, v114
    v_mul_f32 v115, s57, v115
    v_mul_f32 v116, s57, v116
    v_mul_f32 v117, s57, v117
    v_mul_f32 v118, s57, v118
    v_mul_f32 v119, s57, v119
    v_mul_f32 v120, s57, v120
    v_mul_f32 v121, s57, v121
    v_mul_f32 v122, s57, v122
    v_mul_f32 v123, s57, v123
    v_lshrrev_b32 v4, 5, v0
    v_lshl_add_u32 v4, v4, 2, s52
    v_and_b32 v5, 31, v0
    v_lshlrev_b32 v5, 4, v5
    v_mov_b32 v132, 0x3f80
    v_mov_b32 v133, 0
    s_mov_b32 s58, 98304
    v_add_u32 v6, 0, v4
    v_mul_u32_u24 v7, 3277, v6
    v_lshrrev_b32 v7, 16, v7
    v_mul_u32_u24 v8, 20, v7
    v_sub_u32 v6, v6, v8
    v_mul_lo_u32 v7, v7, s58
    v_add_u32 v7, v7, v5
    v_lshrrev_b32 v8, 3, v6
    v_lshl_add_u32 v7, v8, 9, v7
    v_and_b32 v8, 7, v6
    v_lshl_add_u32 v7, v8, 1, v7
    v_cmp_eq_u32 vcc, 16, v6
    v_cvt_pk_bf16_f32 v124, v60, v61
    v_cvt_pk_bf16_f32 v125, v62, v63
    buffer_store_dwordx2 v[124:125], v7, s[36:39], s56 offen offset:0
    v_cvt_pk_bf16_f32 v126, v92, v93
    v_cvt_pk_bf16_f32 v127, v94, v95
    buffer_store_dwordx2 v[126:127], v7, s[36:39], s56 offen offset:1536
    s_and_saveexec_b64 s[60:61], vcc
    buffer_store_dwordx2 v[132:133], v7, s[36:39], s56 offen offset:8
    buffer_store_dwordx2 v[132:133], v7, s[36:39], s56 offen offset:1544
    s_mov_b64 exec, s[60:61]
    v_add_u32 v6, 8, v4
    v_mul_u32_u24 v7, 3277, v6
    v_lshrrev_b32 v7, 16, v7
    v_mul_u32_u24 v8, 20, v7
    v_sub_u32 v6, v6, v8
    v_mul_lo_u32 v7, v7, s58
    v_add_u32 v7, v7, v5
    v_lshrrev_b32 v8, 3, v6
    v_lshl_add_u32 v7, v8, 9, v7
    v_and_b32 v8, 7, v6
    v_lshl_add_u32 v7, v8, 1, v7
    v_cmp_eq_u32 vcc, 16, v6
    v_cvt_pk_bf16_f32 v124, v64, v65
    v_cvt_pk_bf16_f32 v125, v66, v67
    buffer_store_dwordx2 v[124:125], v7, s[36:39], s56 offen offset:0
    v_cvt_pk_bf16_f32 v126, v96, v97
    v_cvt_pk_bf16_f32 v127, v98, v99
    buffer_store_dwordx2 v[126:127], v7, s[36:39], s56 offen offset:1536
    s_and_saveexec_b64 s[60:61], vcc
    buffer_store_dwordx2 v[132:133], v7, s[36:39], s56 offen offset:8
    buffer_store_dwordx2 v[132:133], v7, s[36:39], s56 offen offset:1544
    s_mov_b64 exec, s[60:61]
    v_add_u32 v6, 16, v4
    v_mul_u32_u24 v7, 3277, v6
    v_lshrrev_b32 v7, 16, v7
    v_mul_u32_u24 v8, 20, v7
    v_sub_u32 v6, v6, v8
    v_mul_lo_u32 v7, v7, s58
    v_add_u32 v7, v7, v5
    v_lshrrev_b32 v8, 3, v6
    v_lshl_add_u32 v7, v8, 9, v7
    v_and_b32 v8, 7, v6
    v_lshl_add_u32 v7, v8, 1, v7
    v_cmp_eq_u32 vcc, 16, v6
    v_cvt_pk_bf16_f32 v124, v68, v69
    v_cvt_pk_bf16_f32 v125, v70, v71
    buffer_store_dwordx2 v[124:125], v7, s[36:39], s56 offen offset:0
    v_cvt_pk_bf16_f32 v126, v100, v101
    v_cvt_pk_bf16_f32 v127, v102, v103
    buffer_store_dwordx2 v[126:127], v7, s[36:39], s56 offen offset:1536
    s_and_saveexec_b64 s[60:61], vcc
    buffer_store_dwordx2 v[132:133], v7, s[36:39], s56 offen offset:8
    buffer_store_dwordx2 v[132:133], v7, s[36:39], s56 offen offset:1544
    s_mov_b64 exec, s[60:61]
    v_add_u32 v6, 24, v4
    v_mul_u32_u24 v7, 3277, v6
    v_lshrrev_b32 v7, 16, v7
    v_mul_u32_u24 v8, 20, v7
    v_sub_u32 v6, v6, v8
    v_mul_lo_u32 v7, v7, s58
    v_add_u32 v7, v7, v5
    v_lshrrev_b32 v8, 3, v6
    v_lshl_add_u32 v7, v8, 9, v7
    v_and_b32 v8, 7, v6
    v_lshl_add_u32 v7, v8, 1, v7
    v_cmp_eq_u32 vcc, 16, v6
    v_cvt_pk_bf16_f32 v124, v72, v73
    v_cvt_pk_bf16_f32 v125, v74, v75
    buffer_store_dwordx2 v[124:125], v7, s[36:39], s56 offen offset:0
    v_cvt_pk_bf16_f32 v126, v104, v105
    v_cvt_pk_bf16_f32 v127, v106, v107
    buffer_store_dwordx2 v[126:127], v7, s[36:39], s56 offen offset:1536
    s_and_saveexec_b64 s[60:61], vcc
    buffer_store_dwordx2 v[132:133], v7, s[36:39], s56 offen offset:8
    buffer_store_dwordx2 v[132:133], v7, s[36:39], s56 offen offset:1544
    s_mov_b64 exec, s[60:61]
    v_add_u32 v6, 32, v4
    v_mul_u32_u24 v7, 3277, v6
    v_lshrrev_b32 v7, 16, v7
    v_mul_u32_u24 v8, 20, v7
    v_sub_u32 v6, v6, v8
    v_mul_lo_u32 v7, v7, s58
    v_add_u32 v7, v7, v5
    v_lshrrev_b32 v8, 3, v6
    v_lshl_add_u32 v7, v8, 9, v7
    v_and_b32 v8, 7, v6
    v_lshl_add_u32 v7, v8, 1, v7
    v_cmp_eq_u32 vcc, 16, v6
    v_cvt_pk_bf16_f32 v124, v76, v77
    v_cvt_pk_bf16_f32 v125, v78, v79
    buffer_store_dwordx2 v[124:125], v7, s[36:39], s56 offen offset:0
    v_cvt_pk_bf16_f32 v126, v108, v109
    v_cvt_pk_bf16_f32 v127, v110, v111
    buffer_store_dwordx2 v[126:127], v7, s[36:39], s56 offen offset:1536
    s_and_saveexec_b64 s[60:61], vcc
    buffer_store_dwordx2 v[132:133], v7, s[36:39], s56 offen offset:8
    buffer_store_dwordx2 v[132:133], v7, s[36:39], s56 offen offset:1544
    s_mov_b64 exec, s[60:61]
    v_add_u32 v6, 40, v4
    v_mul_u32_u24 v7, 3277, v6
    v_lshrrev_b32 v7, 16, v7
    v_mul_u32_u24 v8, 20, v7
    v_sub_u32 v6, v6, v8
    v_mul_lo_u32 v7, v7, s58
    v_add_u32 v7, v7, v5
    v_lshrrev_b32 v8, 3, v6
    v_lshl_add_u32 v7, v8, 9, v7
    v_and_b32 v8, 7, v6
    v_lshl_add_u32 v7, v8, 1, v7
    v_cmp_eq_u32 vcc, 16, v6
    v_cvt_pk_bf16_f32 v124, v80, v81
    v_cvt_pk_bf16_f32 v125, v82, v83
    buffer_store_dwordx2 v[124:125], v7, s[36:39], s56 offen offset:0
    v_cvt_pk_bf16_f32 v126, v112, v113
    v_cvt_pk_bf16_f32 v127, v114, v115
    buffer_store_dwordx2 v[126:127], v7, s[36:39], s56 offen offset:1536
    s_and_saveexec_b64 s[60:61], vcc
    buffer_store_dwordx2 v[132:133], v7, s[36:39], s56 offen offset:8
    buffer_store_dwordx2 v[132:133], v7, s[36:39], s56 offen offset:1544
    s_mov_b64 exec, s[60:61]
    v_add_u32 v6, 48, v4
    v_mul_u32_u24 v7, 3277, v6
    v_lshrrev_b32 v7, 16, v7
    v_mul_u32_u24 v8, 20, v7
    v_sub_u32 v6, v6, v8
    v_mul_lo_u32 v7, v7, s58
    v_add_u32 v7, v7, v5
    v_lshrrev_b32 v8, 3, v6
    v_lshl_add_u32 v7, v8, 9, v7
    v_and_b32 v8, 7, v6
    v_lshl_add_u32 v7, v8, 1, v7
    v_cmp_eq_u32 vcc, 16, v6
    v_cvt_pk_bf16_f32 v124, v84, v85
    v_cvt_pk_bf16_f32 v125, v86, v87
    buffer_store_dwordx2 v[124:125], v7, s[36:39], s56 offen offset:0
    v_cvt_pk_bf16_f32 v126, v116, v117
    v_cvt_pk_bf16_f32 v127, v118, v119
    buffer_store_dwordx2 v[126:127], v7, s[36:39], s56 offen offset:1536
    s_and_saveexec_b64 s[60:61], vcc
    buffer_store_dwordx2 v[132:133], v7, s[36:39], s56 offen offset:8
    buffer_store_dwordx2 v[132:133], v7, s[36:39], s56 offen offset:1544
    s_mov_b64 exec, s[60:61]
    v_add_u32 v6, 56, v4
    v_mul_u32_u24 v7, 3277, v6
    v_lshrrev_b32 v7, 16, v7
    v_mul_u32_u24 v8, 20, v7
    v_sub_u32 v6, v6, v8
    v_mul_lo_u32 v7, v7, s58
    v_add_u32 v7, v7, v5
    v_lshrrev_b32 v8, 3, v6
    v_lshl_add_u32 v7, v8, 9, v7
    v_and_b32 v8, 7, v6
    v_lshl_add_u32 v7, v8, 1, v7
    v_cmp_eq_u32 vcc, 16, v6
    v_cvt_pk_bf16_f32 v124, v88, v89
    v_cvt_pk_bf16_f32 v125, v90, v91
    buffer_store_dwordx2 v[124:125], v7, s[36:39], s56 offen offset:0
    v_cvt_pk_bf16_f32 v126, v120, v121
    v_cvt_pk_bf16_f32 v127, v122, v123
    buffer_store_dwordx2 v[126:127], v7, s[36:39], s56 offen offset:1536
    s_and_saveexec_b64 s[60:61], vcc
    buffer_store_dwordx2 v[132:133], v7, s[36:39], s56 offen offset:8
    buffer_store_dwordx2 v[132:133], v7, s[36:39], s56 offen offset:1544
    s_mov_b64 exec, s[60:61]
    s_endpgm
qkv_vpath:
    s_waitcnt vmcnt(6)
    s_barrier
    ds_read_b128 v[28:31], v10 offset:0
    ds_read_b128 v[32:35], v10 offset:4096
    ds_read_b64_tr_b16 v[44:45], v22 offset:0
    ds_read_b64_tr_b16 v[46:47], v22 offset:256
    ds_read_b64_tr_b16 v[48:49], v23 offset:0
    ds_read_b64_tr_b16 v[50:51], v23 offset:256
    ds_read_b128 v[36:39], v11 offset:0
    ds_read_b128 v[40:43], v11 offset:4096
    ds_read_b64_tr_b16 v[52:53], v22 offset:1024
    ds_read_b64_tr_b16 v[54:55], v22 offset:1280
    ds_read_b64_tr_b16 v[56:57], v23 offset:1024
    ds_read_b64_tr_b16 v[58:59], v23 offset:1280
    s_waitcnt lgkmcnt(6)
    v_mfma_f32_32x32x16_bf16 v[60:75], v[28:31], v[44:47], v[60:75]
    s_add_u32 s62, s62, 1
    s_cmp_eq_u32 s62, 10
    s_cselect_b32 s63, 4294966016, 0
    s_cselect_b32 s64, 4292509696, 0
    s_cselect_b32 s62, 0, s62
    s_add_u32 s63, s63, 128
    s_add_u32 s64, s64, 245760
    s_add_u32 m0, s46, 98304
    s_nop 0
    buffer_load_dwordx4 v1, s[28:31], s40 offen lds
    s_add_u32 s40, s40, s63
    v_mfma_f32_32x32x16_bf16 v[76:91], v[28:31], v[48:51], v[76:91]
    v_mfma_f32_32x32x16_bf16 v[92:107], v[32:35], v[44:47], v[92:107]
    s_add_u32 m0, s47, 98304
    s_nop 0
    buffer_load_dwordx4 v2, s[28:31], s41 offen lds
    s_add_u32 s41, s41, s63
    v_mfma_f32_32x32x16_bf16 v[108:123], v[32:35], v[48:51], v[108:123]
    ds_read_b128 v[28:31], v12 offset:0
    ds_read_b128 v[32:35], v12 offset:4096
    ds_read_b64_tr_b16 v[44:45], v22 offset:2048
    ds_read_b64_tr_b16 v[46:47], v22 offset:2304
    ds_read_b64_tr_b16 v[48:49], v23 offset:2048
    ds_read_b64_tr_b16 v[50:51], v23 offset:2304
    s_waitcnt lgkmcnt(6)
    v_mfma_f32_32x32x16_bf16 v[60:75], v[36:39], v[52:55], v[60:75]
    v_mfma_f32_32x32x16_bf16 v[76:91], v[36:39], v[56:59], v[76:91]
    s_add_u32 m0, s48, 98304
    s_nop 0
    buffer_load_dwordx4 v1, s[28:31], s42 offen lds
    s_add_u32 s42, s42, s63
    v_mfma_f32_32x32x16_bf16 v[92:107], v[40:43], v[52:55], v[92:107]
    v_mfma_f32_32x32x16_bf16 v[108:123], v[40:43], v[56:59], v[108:123]
    ds_read_b128 v[36:39], v13 offset:0
    ds_read_b128 v[40:43], v13 offset:4096
    ds_read_b64_tr_b16 v[52:53], v22 offset:3072
    ds_read_b64_tr_b16 v[54:55], v22 offset:3328
    ds_read_b64_tr_b16 v[56:57], v23 offset:3072
    ds_read_b64_tr_b16 v[58:59], v23 offset:3328
    s_waitcnt lgkmcnt(6)
    v_mfma_f32_32x32x16_bf16 v[60:75], v[28:31], v[44:47], v[60:75]
    s_add_u32 m0, s49, 98304
    s_nop 0
    buffer_load_dwordx4 v2, s[28:31], s43 offen lds
    s_add_u32 s43, s43, s63
    v_mfma_f32_32x32x16_bf16 v[76:91], v[28:31], v[48:51], v[76:91]
    v_mfma_f32_32x32x16_bf16 v[92:107], v[32:35], v[44:47], v[92:107]
    s_add_u32 m0, s50, 98304
    s_nop 0
    buffer_load_dwordx4 v3, s[32:35], s44 offen lds
    s_add_u32 s44, s44, s64
    v_mfma_f32_32x32x16_bf16 v[108:123], v[32:35], v[48:51], v[108:123]
    s_waitcnt lgkmcnt(0)
    v_mfma_f32_32x32x16_bf16 v[60:75], v[36:39], v[52:55], v[60:75]
    v_mfma_f32_32x32x16_bf16 v[76:91], v[36:39], v[56:59], v[76:91]
    s_add_u32 m0, s51, 98304
    s_nop 0
    buffer_load_dwordx4 v3, s[32:35], s45 offen lds
    s_add_u32 s45, s45, s64
    v_mfma_f32_32x32x16_bf16 v[92:107], v[40:43], v[52:55], v[92:107]
    v_mfma_f32_32x32x16_bf16 v[108:123], v[40:43], v[56:59], v[108:123]
    s_waitcnt vmcnt(6)
    s_barrier
    ds_read_b128 v[28:31], v14 offset:0
    ds_read_b128 v[32:35], v14 offset:4096
    ds_read_b64_tr_b16 v[44:45], v24 offset:0
    ds_read_b64_tr_b16 v[46:47], v24 offset:256
    ds_read_b64_tr_b16 v[48:49], v25 offset:0
    ds_read_b64_tr_b16 v[50:51], v25 offset:256
    ds_read_b128 v[36:39], v15 offset:0
    ds_read_b128 v[40:43], v15 offset:4096
    ds_read_b64_tr_b16 v[52:53], v24 offset:1024
    ds_read_b64_tr_b16 v[54:55], v24 offset:1280
    ds_read_b64_tr_b16 v[56:57], v25 offset:1024
    ds_read_b64_tr_b16 v[58:59], v25 offset:1280
    s_waitcnt lgkmcnt(6)
    v_mfma_f32_32x32x16_bf16 v[60:75], v[28:31], v[44:47], v[60:75]
    s_add_u32 s62, s62, 1
    s_cmp_eq_u32 s62, 10
    s_cselect_b32 s63, 4294966016, 0
    s_cselect_b32 s64, 4292509696, 0
    s_cselect_b32 s62, 0, s62
    s_add_u32 s63, s63, 128
    s_add_u32 s64, s64, 245760
    s_add_u32 m0, s46, 0
    s_nop 0
    buffer_load_dwordx4 v1, s[28:31], s40 offen lds
    s_add_u32 s40, s40, s63
    v_mfma_f32_32x32x16_bf16 v[76:91], v[28:31], v[48:51], v[76:91]
    v_mfma_f32_32x32x16_bf16 v[92:107], v[32:35], v[44:47], v[92:107]
    s_add_u32 m0, s47, 0
    s_nop 0
    buffer_load_dwordx4 v2, s[28:31], s41 offen lds
    s_add_u32 s41, s41, s63
    v_mfma_f32_32x32x16_bf16 v[108:123], v[32:35], v[48:51], v[108:123]
    ds_read_b128 v[28:31], v16 offset:0
    ds_read_b128 v[32:35], v16 offset:4096
    ds_read_b64_tr_b16 v[44:45], v24 offset:2048
    ds_read_b64_tr_b16 v[46:47], v24 offset:2304
    ds_read_b64_tr_b16 v[48:49], v25 offset:2048
    ds_read_b64_tr_b16 v[50:51], v25 offset:2304
    s_waitcnt lgkmcnt(6)
    v_mfma_f32_32x32x16_bf16 v[60:75], v[36:39], v[52:55], v[60:75]
    v_mfma_f32_32x32x16_bf16 v[76:91], v[36:39], v[56:59], v[76:91]
    s_add_u32 m0, s48, 0
    s_nop 0
    buffer_load_dwordx4 v1, s[28:31], s42 offen lds
    s_add_u32 s42, s42, s63
    v_mfma_f32_32x32x16_bf16 v[92:107], v[40:43], v[52:55], v[92:107]
    v_mfma_f32_32x32x16_bf16 v[108:123], v[40:43], v[56:59], v[108:123]
    ds_read_b128 v[36:39], v17 offset:0
    ds_read_b128 v[40:43], v17 offset:4096
    ds_read_b64_tr_b16 v[52:53], v24 offset:3072
    ds_read_b64_tr_b16 v[54:55], v24 offset:3328
    ds_read_b64_tr_b16 v[56:57], v25 offset:3072
    ds_read_b64_tr_b16 v[58:59], v25 offset:3328
    s_waitcnt lgkmcnt(6)
    v_mfma_f32_32x32x16_bf16 v[60:75], v[28:31], v[44:47], v[60:75]
    s_add_u32 m0, s49, 0
    s_nop 0
    buffer_load_dwordx4 v2, s[28:31], s43 offen lds
    s_add_u32 s43, s43, s63
    v_mfma_f32_32x32x16_bf16 v[76:91], v[28:31], v[48:51], v[76:91]
    v_mfma_f32_32x32x16_bf16 v[92:107], v[32:35], v[44:47], v[92:107]
    s_add_u32 m0, s50, 0
    s_nop 0
    buffer_load_dwordx4 v3, s[32:35], s44 offen lds
    s_add_u32 s44, s44, s64
    v_mfma_f32_32x32x16_bf16 v[108:123], v[32:35], v[48:51], v[108:123]
    s_waitcnt lgkmcnt(0)
    v_mfma_f32_32x32x16_bf16 v[60:75], v[36:39], v[52:55], v[60:75]
    v_mfma_f32_32x32x16_bf16 v[76:91], v[36:39], v[56:59], v[76:91]
    s_add_u32 m0, s51, 0
    s_nop 0
    buffer_load_dwordx4 v3, s[32:35], s45 offen lds
    s_add_u32 s45, s45, s64
    v_mfma_f32_32x32x16_bf16 v[92:107], v[40:43], v[52:55], v[92:107]
    v_mfma_f32_32x32x16_bf16 v[108:123], v[40:43], v[56:59], v[108:123]
    s_waitcnt vmcnt(6)
    s_barrier
    ds_read_b128 v[28:31], v18 offset:0
    ds_read_b128 v[32:35], v18 offset:4096
    ds_read_b64_tr_b16 v[44:45], v26 offset:0
    ds_read_b64_tr_b16 v[46:47], v26 offset:256
    ds_read_b64_tr_b16 v[48:49], v27 offset:0
    ds_read_b64_tr_b16 v[50:51], v27 offset:256
    ds_read_b128 v[36:39], v19 offset:0
    ds_read_b128 v[40:43], v19 offset:4096
    ds_read_b64_tr_b16 v[52:53], v26 offset:1024
    ds_read_b64_tr_b16 v[54:55], v26 offset:1280
    ds_read_b64_tr_b16 v[56:57], v27 offset:1024
    ds_read_b64_tr_b16 v[58:59], v27 offset:1280
    s_waitcnt lgkmcnt(6)
    v_mfma_f32_32x32x16_bf16 v[60:75], v[28:31], v[44:47], v[60:75]
    s_add_u32 s62, s62, 1
    s_cmp_eq_u32 s62, 10
    s_cselect_b32 s63, 4294966016, 0
    s_cselect_b32 s64, 4292509696, 0
    s_cselect_b32 s62, 0, s62
    s_add_u32 s63, s63, 128
    s_add_u32 s64, s64, 245760
    s_add_u32 m0, s46, 49152
    s_nop 0
    buffer_load_dwordx4 v1, s[28:31], s40 offen lds
    s_add_u32 s40, s40, s63
    v_mfma_f32_32x32x16_bf16 v[76:91], v[28:31], v[48:51], v[76:91]
    v_mfma_f32_32x32x16_bf16 v[92:107], v[32:35], v[44:47], v[92:107]
    s_add_u32 m0, s47, 49152
    s_nop 0
    buffer_load_dwordx4 v2, s[28:31], s41 offen lds
    s_add_u32 s41, s41, s63
    v_mfma_f32_32x32x16_bf16 v[108:123], v[32:35], v[48:51], v[108:123]
    ds_read_b128 v[28:31], v20 offset:0
    ds_read_b128 v[32:35], v20 offset:4096
    ds_read_b64_tr_b16 v[44:45], v26 offset:2048
    ds_read_b64_tr_b16 v[46:47], v26 offset:2304
    ds_read_b64_tr_b16 v[48:49], v27 offset:2048
    ds_read_b64_tr_b16 v[50:51], v27 offset:2304
    s_waitcnt lgkmcnt(6)
    v_mfma_f32_32x32x16_bf16 v[60:75], v[36:39], v[52:55], v[60:75]
    v_mfma_f32_32x32x16_bf16 v[76:91], v[36:39], v[56:59], v[76:91]
    s_add_u32 m0, s48, 49152
    s_nop 0
    buffer_load_dwordx4 v1, s[28:31], s42 offen lds
    s_add_u32 s42, s42, s63
    v_mfma_f32_32x32x16_bf16 v[92:107], v[40:43], v[52:55], v[92:107]
    v_mfma_f32_32x32x16_bf16 v[108:123], v[40:43], v[56:59], v[108:123]
    ds_read_b128 v[36:39], v21 offset:0
    ds_read_b128 v[40:43], v21 offset:4096
    ds_read_b64_tr_b16 v[52:53], v26 offset:3072
    ds_read_b64_tr_b16 v[54:55], v26 offset:3328
    ds_read_b64_tr_b16 v[56:57], v27 offset:3072
    ds_read_b64_tr_b16 v[58:59], v27 offset:3328
    s_waitcnt lgkmcnt(6)
    v_mfma_f32_32x32x16_bf16 v[60:75], v[28:31], v[44:47], v[60:75]
    s_add_u32 m0, s49, 49152
    s_nop 0
    buffer_load_dwordx4 v2, s[28:31], s43 offen lds
    s_add_u32 s43, s43, s63
    v_mfma_f32_32x32x16_bf16 v[76:91], v[28:31], v[48:51], v[76:91]
    v_mfma_f32_32x32x16_bf16 v[92:107], v[32:35], v[44:47], v[92:107]
    s_add_u32 m0, s50, 49152
    s_nop 0
    buffer_load_dwordx4 v3, s[32:35], s44 offen lds
    s_add_u32 s44, s44, s64
    v_mfma_f32_32x32x16_bf16 v[108:123], v[32:35], v[48:51], v[108:123]
    s_waitcnt lgkmcnt(0)
    v_mfma_f32_32x32x16_bf16 v[60:75], v[36:39], v[52:55], v[60:75]
    v_mfma_f32_32x32x16_bf16 v[76:91], v[36:39], v[56:59], v[76:91]
    s_add_u32 m0, s51, 49152
    s_nop 0
    buffer_load_dwordx4 v3, s[32:35], s45 offen lds
    s_add_u32 s45, s45, s64
    v_mfma_f32_32x32x16_bf16 v[92:107], v[40:43], v[52:55], v[92:107]
    v_mfma_f32_32x32x16_bf16 v[108:123], v[40:43], v[56:59], v[108:123]
    s_waitcnt vmcnt(6)
    s_barrier
    ds_read_b128 v[28:31], v10 offset:0
    ds_read_b128 v[32:35], v10 offset:4096
    ds_read_b64_tr_b16 v[44:45], v22 offset:0
    ds_read_b64_tr_b16 v[46:47], v22 offset:256
    ds_read_b64_tr_b16 v[48:49], v23 offset:0
    ds_read_b64_tr_b16 v[50:51], v23 offset:256
    ds_read_b128 v[36:39], v11 offset:0
    ds_read_b128 v[40:43], v11 offset:4096
    ds_read_b64_tr_b16 v[52:53], v22 offset:1024
    ds_read_b64_tr_b16 v[54:55], v22 offset:1280
    ds_read_b64_tr_b16 v[56:57], v23 offset:1024
    ds_read_b64_tr_b16 v[58:59], v23 offset:1280
    s_waitcnt lgkmcnt(6)
    v_mfma_f32_32x32x16_bf16 v[60:75], v[28:31], v[44:47], v[60:75]
    s_add_u32 s62, s62, 1
    s_cmp_eq_u32 s62, 10
    s_cselect_b32 s63, 4294966016, 0
    s_cselect_b32 s64, 4292509696, 0
    s_cselect_b32 s62, 0, s62
    s_add_u32 s63, s63, 128
    s_add_u32 s64, s64, 245760
    s_add_u32 m0, s46, 98304
    s_nop 0
    buffer_load_dwordx4 v1, s[28:31], s40 offen lds
    s_add_u32 s40, s40, s63
    v_mfma_f32_32x32x16_bf16 v[76:91], v[28:31], v[48:51], v[76:91]
    v_mfma_f32_32x32x16_bf16 v[92:107], v[32:35], v[44:47], v[92:107]
    s_add_u32 m0, s47, 98304
    s_nop 0
    buffer_load_dwordx4 v2, s[28:31], s41 offen lds
    s_add_u32 s41, s41, s63
    v_mfma_f32_32x32x16_bf16 v[108:123], v[32:35], v[48:51], v[108:123]
    ds_read_b128 v[28:31], v12 offset:0
    ds_read_b128 v[32:35], v12 offset:4096
    ds_read_b64_tr_b16 v[44:45], v22 offset:2048
    ds_read_b64_tr_b16 v[46:47], v22 offset:2304
    ds_read_b64_tr_b16 v[48:49], v23 offset:2048
    ds_read_b64_tr_b16 v[50:51], v23 offset:2304
    s_waitcnt lgkmcnt(6)
    v_mfma_f32_32x32x16_bf16 v[60:75], v[36:39], v[52:55], v[60:75]
    v_mfma_f32_32x32x16_bf16 v[76:91], v[36:39], v[56:59], v[76:91]
    s_add_u32 m0, s48, 98304
    s_nop 0
    buffer_load_dwordx4 v1, s[28:31], s42 offen lds
    s_add_u32 s42, s42, s63
    v_mfma_f32_32x32x16_bf16 v[92:107], v[40:43], v[52:55], v[92:107]
    v_mfma_f32_32x32x16_bf16 v[108:123], v[40:43], v[56:59], v[108:123]
    ds_read_b128 v[36:39], v13 offset:0
    ds_read_b128 v[40:43], v13 offset:4096
    ds_read_b64_tr_b16 v[52:53], v22 offset:3072
    ds_read_b64_tr_b16 v[54:55], v22 offset:3328
    ds_read_b64_tr_b16 v[56:57], v23 offset:3072
    ds_read_b64_tr_b16 v[58:59], v23 offset:3328
    s_waitcnt lgkmcnt(6)
    v_mfma_f32_32x32x16_bf16 v[60:75], v[28:31], v[44:47], v[60:75]
    s_add_u32 m0, s49, 98304
    s_nop 0
    buffer_load_dwordx4 v2, s[28:31], s43 offen lds
    s_add_u32 s43, s43, s63
    v_mfma_f32_32x32x16_bf16 v[76:91], v[28:31], v[48:51], v[76:91]
    v_mfma_f32_32x32x16_bf16 v[92:107], v[32:35], v[44:47], v[92:107]
    s_add_u32 m0, s50, 98304
    s_nop 0
    buffer_load_dwordx4 v3, s[32:35], s44 offen lds
    s_add_u32 s44, s44, s64
    v_mfma_f32_32x32x16_bf16 v[108:123], v[32:35], v[48:51], v[108:123]
    s_waitcnt lgkmcnt(0)
    v_mfma_f32_32x32x16_bf16 v[60:75], v[36:39], v[52:55], v[60:75]
    v_mfma_f32_32x32x16_bf16 v[76:91], v[36:39], v[56:59], v[76:91]
    s_add_u32 m0, s51, 98304
    s_nop 0
    buffer_load_dwordx4 v3, s[32:35], s45 offen lds
    s_add_u32 s45, s45, s64
    v_mfma_f32_32x32x16_bf16 v[92:107], v[40:43], v[52:55], v[92:107]
    v_mfma_f32_32x32x16_bf16 v[108:123], v[40:43], v[56:59], v[108:123]
    s_waitcnt vmcnt(6)
    s_barrier
    ds_read_b128 v[28:31], v14 offset:0
    ds_read_b128 v[32:35], v14 offset:4096
    ds_read_b64_tr_b16 v[44:45], v24 offset:0
    ds_read_b64_tr_b16 v[46:47], v24 offset:256
    ds_read_b64_tr_b16 v[48:49], v25 offset:0
    ds_read_b64_tr_b16 v[50:51], v25 offset:256
    ds_read_b128 v[36:39], v15 offset:0
    ds_read_b128 v[40:43], v15 offset:4096
    ds_read_b64_tr_b16 v[52:53], v24 offset:1024
    ds_read_b64_tr_b16 v[54:55], v24 offset:1280
    ds_read_b64_tr_b16 v[56:57], v25 offset:1024
    ds_read_b64_tr_b16 v[58:59], v25 offset:1280
    s_waitcnt lgkmcnt(6)
    v_mfma_f32_32x32x16_bf16 v[60:75], v[28:31], v[44:47], v[60:75]
    s_add_u32 s62, s62, 1
    s_cmp_eq_u32 s62, 10
    s_cselect_b32 s63, 4294966016, 0
    s_cselect_b32 s64, 4292509696, 0
    s_cselect_b32 s62, 0, s62
    s_add_u32 s63, s63, 128
    s_add_u32 s64, s64, 245760
    s_add_u32 m0, s46, 0
    s_nop 0
    buffer_load_dwordx4 v1, s[28:31], s40 offen lds
    s_add_u32 s40, s40, s63
    v_mfma_f32_32x32x16_bf16 v[76:91], v[28:31], v[48:51], v[76:91]
    v_mfma_f32_32x32x16_bf16 v[92:107], v[32:35], v[44:47], v[92:107]
    s_add_u32 m0, s47, 0
    s_nop 0
    buffer_load_dwordx4 v2, s[28:31], s41 offen lds
    s_add_u32 s41, s41, s63
    v_mfma_f32_32x32x16_bf16 v[108:123], v[32:35], v[48:51], v[108:123]
    ds_read_b128 v[28:31], v16 offset:0
    ds_read_b128 v[32:35], v16 offset:4096
    ds_read_b64_tr_b16 v[44:45], v24 offset:2048
    ds_read_b64_tr_b16 v[46:47], v24 offset:2304
    ds_read_b64_tr_b16 v[48:49], v25 offset:2048
    ds_read_b64_tr_b16 v[50:51], v25 offset:2304
    s_waitcnt lgkmcnt(6)
    v_mfma_f32_32x32x16_bf16 v[60:75], v[36:39], v[52:55], v[60:75]
    v_mfma_f32_32x32x16_bf16 v[76:91], v[36:39], v[56:59], v[76:91]
    s_add_u32 m0, s48, 0
    s_nop 0
    buffer_load_dwordx4 v1, s[28:31], s42 offen lds
    s_add_u32 s42, s42, s63
    v_mfma_f32_32x32x16_bf16 v[92:107], v[40:43], v[52:55], v[92:107]
    v_mfma_f32_32x32x16_bf16 v[108:123], v[40:43], v[56:59], v[108:123]
    ds_read_b128 v[36:39], v17 offset:0
    ds_read_b128 v[40:43], v17 offset:4096
    ds_read_b64_tr_b16 v[52:53], v24 offset:3072
    ds_read_b64_tr_b16 v[54:55], v24 offset:3328
    ds_read_b64_tr_b16 v[56:57], v25 offset:3072
    ds_read_b64_tr_b16 v[58:59], v25 offset:3328
    s_waitcnt lgkmcnt(6)
    v_mfma_f32_32x32x16_bf16 v[60:75], v[28:31], v[44:47], v[60:75]
    s_add_u32 m0, s49, 0
    s_nop 0
    buffer_load_dwordx4 v2, s[28:31], s43 offen lds
    s_add_u32 s43, s43, s63
    v_mfma_f32_32x32x16_bf16 v[76:91], v[28:31], v[48:51], v[76:91]
    v_mfma_f32_32x32x16_bf16 v[92:107], v[32:35], v[44:47], v[92:107]
    s_add_u32 m0, s50, 0
    s_nop 0
    buffer_load_dwordx4 v3, s[32:35], s44 offen lds
    s_add_u32 s44, s44, s64
    v_mfma_f32_32x32x16_bf16 v[108:123], v[32:35], v[48:51], v[108:123]
    s_waitcnt lgkmcnt(0)
    v_mfma_f32_32x32x16_bf16 v[60:75], v[36:39], v[52:55], v[60:75]
    v_mfma_f32_32x32x16_bf16 v[76:91], v[36:39], v[56:59], v[76:91]
    s_add_u32 m0, s51, 0
    s_nop 0
    buffer_load_dwordx4 v3, s[32:35], s45 offen lds
    s_add_u32 s45, s45, s64
    v_mfma_f32_32x32x16_bf16 v[92:107], v[40:43], v[52:55], v[92:107]
    v_mfma_f32_32x32x16_bf16 v[108:123], v[40:43], v[56:59], v[108:123]
    s_waitcnt vmcnt(6)
    s_barrier
    ds_read_b128 v[28:31], v18 offset:0
    ds_read_b128 v[32:35], v18 offset:4096
    ds_read_b64_tr_b16 v[44:45], v26 offset:0
    ds_read_b64_tr_b16 v[46:47], v26 offset:256
    ds_read_b64_tr_b16 v[48:49], v27 offset:0
    ds_read_b64_tr_b16 v[50:51], v27 offset:256
    ds_read_b128 v[36:39], v19 offset:0
    ds_read_b128 v[40:43], v19 offset:4096
    ds_read_b64_tr_b16 v[52:53], v26 offset:1024
    ds_read_b64_tr_b16 v[54:55], v26 offset:1280
    ds_read_b64_tr_b16 v[56:57], v27 offset:1024
    ds_read_b64_tr_b16 v[58:59], v27 offset:1280
    s_waitcnt lgkmcnt(6)
    v_mfma_f32_32x32x16_bf16 v[60:75], v[28:31], v[44:47], v[60:75]
    s_add_u32 s62, s62, 1
    s_cmp_eq_u32 s62, 10
    s_cselect_b32 s63, 4294966016, 0
    s_cselect_b32 s64, 4292509696, 0
    s_cselect_b32 s62, 0, s62
    s_add_u32 s63, s63, 128
    s_add_u32 s64, s64, 245760
    s_add_u32 m0, s46, 49152
    s_nop 0
    buffer_load_dwordx4 v1, s[28:31], s40 offen lds
    s_add_u32 s40, s40, s63
    v_mfma_f32_32x32x16_bf16 v[76:91], v[28:31], v[48:51], v[76:91]
    v_mfma_f32_32x32x16_bf16 v[92:107], v[32:35], v[44:47], v[92:107]
    s_add_u32 m0, s47, 49152
    s_nop 0
    buffer_load_dwordx4 v2, s[28:31], s41 offen lds
    s_add_u32 s41, s41, s63
    v_mfma_f32_32x32x16_bf16 v[108:123], v[32:35], v[48:51], v[108:123]
    ds_read_b128 v[28:31], v20 offset:0
    ds_read_b128 v[32:35], v20 offset:4096
    ds_read_b64_tr_b16 v[44:45], v26 offset:2048
    ds_read_b64_tr_b16 v[46:47], v26 offset:2304
    ds_read_b64_tr_b16 v[48:49], v27 offset:2048
    ds_read_b64_tr_b16 v[50:51], v27 offset:2304
    s_waitcnt lgkmcnt(6)
    v_mfma_f32_32x32x16_bf16 v[60:75], v[36:39], v[52:55], v[60:75]
    v_mfma_f32_32x32x16_bf16 v[76:91], v[36:39], v[56:59], v[76:91]
    s_add_u32 m0, s48, 49152
    s_nop 0
    buffer_load_dwordx4 v1, s[28:31], s42 offen lds
    s_add_u32 s42, s42, s63
    v_mfma_f32_32x32x16_bf16 v[92:107], v[40:43], v[52:55], v[92:107]
    v_mfma_f32_32x32x16_bf16 v[108:123], v[40:43], v[56:59], v[108:123]
    ds_read_b128 v[36:39], v21 offset:0
    ds_read_b128 v[40:43], v21 offset:4096
    ds_read_b64_tr_b16 v[52:53], v26 offset:3072
    ds_read_b64_tr_b16 v[54:55], v26 offset:3328
    ds_read_b64_tr_b16 v[56:57], v27 offset:3072
    ds_read_b64_tr_b16 v[58:59], v27 offset:3328
    s_waitcnt lgkmcnt(6)
    v_mfma_f32_32x32x16_bf16 v[60:75], v[28:31], v[44:47], v[60:75]
    s_add_u32 m0, s49, 49152
    s_nop 0
    buffer_load_dwordx4 v2, s[28:31], s43 offen lds
    s_add_u32 s43, s43, s63
    v_mfma_f32_32x32x16_bf16 v[76:91], v[28:31], v[48:51], v[76:91]
    v_mfma_f32_32x32x16_bf16 v[92:107], v[32:35], v[44:47], v[92:107]
    s_add_u32 m0, s50, 49152
    s_nop 0
    buffer_load_dwordx4 v3, s[32:35], s44 offen lds
    s_add_u32 s44, s44, s64
    v_mfma_f32_32x32x16_bf16 v[108:123], v[32:35], v[48:51], v[108:123]
    s_waitcnt lgkmcnt(0)
    v_mfma_f32_32x32x16_bf16 v[60:75], v[36:39], v[52:55], v[60:75]
    v_mfma_f32_32x32x16_bf16 v[76:91], v[36:39], v[56:59], v[76:91]
    s_add_u32 m0, s51, 49152
    s_nop 0
    buffer_load_dwordx4 v3, s[32:35], s45 offen lds
    s_add_u32 s45, s45, s64
    v_mfma_f32_32x32x16_bf16 v[92:107], v[40:43], v[52:55], v[92:107]
    v_mfma_f32_32x32x16_bf16 v[108:123], v[40:43], v[56:59], v[108:123]
    s_waitcnt vmcnt(6)
    s_barrier
    ds_read_b128 v[28:31], v10 offset:0
    ds_read_b128 v[32:35], v10 offset:4096
    ds_read_b64_tr_b16 v[44:45], v22 offset:0
    ds_read_b64_tr_b16 v[46:47], v22 offset:256
    ds_read_b64_tr_b16 v[48:49], v23 offset:0
    ds_read_b64_tr_b16 v[50:51], v23 offset:256
    ds_read_b128 v[36:39], v11 offset:0
    ds_read_b128 v[40:43], v11 offset:4096
    ds_read_b64_tr_b16 v[52:53], v22 offset:1024
    ds_read_b64_tr_b16 v[54:55], v22 offset:1280
    ds_read_b64_tr_b16 v[56:57], v23 offset:1024
    ds_read_b64_tr_b16 v[58:59], v23 offset:1280
    s_waitcnt lgkmcnt(6)
    v_mfma_f32_32x32x16_bf16 v[60:75], v[28:31], v[44:47], v[60:75]
    s_add_u32 s62, s62, 1
    s_cmp_eq_u32 s62, 10
    s_cselect_b32 s63, 4294966016, 0
    s_cselect_b32 s64, 4292509696, 0
    s_cselect_b32 s62, 0, s62
    s_add_u32 s63, s63, 128
    s_add_u32 s64, s64, 245760
    s_add_u32 m0, s46, 98304
    s_nop 0
    buffer_load_dwordx4 v1, s[28:31], s40 offen lds
    s_add_u32 s40, s40, s63
    v_mfma_f32_32x32x16_bf16 v[76:91], v[28:31], v[48:51], v[76:91]
    v_mfma_f32_32x32x16_bf16 v[92:107], v[32:35], v[44:47], v[92:107]
    s_add_u32 m0, s47, 98304
    s_nop 0
    buffer_load_dwordx4 v2, s[28:31], s41 offen lds
    s_add_u32 s41, s41, s63
    v_mfma_f32_32x32x16_bf16 v[108:123], v[32:35], v[48:51], v[108:123]
    ds_read_b128 v[28:31], v12 offset:0
    ds_read_b128 v[32:35], v12 offset:4096
    ds_read_b64_tr_b16 v[44:45], v22 offset:2048
    ds_read_b64_tr_b16 v[46:47], v22 offset:2304
    ds_read_b64_tr_b16 v[48:49], v23 offset:2048
    ds_read_b64_tr_b16 v[50:51], v23 offset:2304
    s_waitcnt lgkmcnt(6)
    v_mfma_f32_32x32x16_bf16 v[60:75], v[36:39], v[52:55], v[60:75]
    v_mfma_f32_32x32x16_bf16 v[76:91], v[36:39], v[56:59], v[76:91]
    s_add_u32 m0, s48, 98304
    s_nop 0
    buffer_load_dwordx4 v1, s[28:31], s42 offen lds
    s_add_u32 s42, s42, s63
    v_mfma_f32_32x32x16_bf16 v[92:107], v[40:43], v[52:55], v[92:107]
    v_mfma_f32_32x32x16_bf16 v[108:123], v[40:43], v[56:59], v[108:123]
    ds_read_b128 v[36:39], v13 offset:0
    ds_read_b128 v[40:43], v13 offset:4096
    ds_read_b64_tr_b16 v[52:53], v22 offset:3072
    ds_read_b64_tr_b16 v[54:55], v22 offset:3328
    ds_read_b64_tr_b16 v[56:57], v23 offset:3072
    ds_read_b64_tr_b16 v[58:59], v23 offset:3328
    s_waitcnt lgkmcnt(6)
    v_mfma_f32_32x32x16_bf16 v[60:75], v[28:31], v[44:47], v[60:75]
    s_add_u32 m0, s49, 98304
    s_nop 0
    buffer_load_dwordx4 v2, s[28:31], s43 offen lds
    s_add_u32 s43, s43, s63
    v_mfma_f32_32x32x16_bf16 v[76:91], v[28:31], v[48:51], v[76:91]
    v_mfma_f32_32x32x16_bf16 v[92:107], v[32:35], v[44:47], v[92:107]
    s_add_u32 m0, s50, 98304
    s_nop 0
    buffer_load_dwordx4 v3, s[32:35], s44 offen lds
    s_add_u32 s44, s44, s64
    v_mfma_f32_32x32x16_bf16 v[108:123], v[32:35], v[48:51], v[108:123]
    s_waitcnt lgkmcnt(0)
    v_mfma_f32_32x32x16_bf16 v[60:75], v[36:39], v[52:55], v[60:75]
    v_mfma_f32_32x32x16_bf16 v[76:91], v[36:39], v[56:59], v[76:91]
    s_add_u32 m0, s51, 98304
    s_nop 0
    buffer_load_dwordx4 v3, s[32:35], s45 offen lds
    s_add_u32 s45, s45, s64
    v_mfma_f32_32x32x16_bf16 v[92:107], v[40:43], v[52:55], v[92:107]
    v_mfma_f32_32x32x16_bf16 v[108:123], v[40:43], v[56:59], v[108:123]
    s_waitcnt vmcnt(6)
    s_barrier
    ds_read_b128 v[28:31], v14 offset:0
    ds_read_b128 v[32:35], v14 offset:4096
    ds_read_b64_tr_b16 v[44:45], v24 offset:0
    ds_read_b64_tr_b16 v[46:47], v24 offset:256
    ds_read_b64_tr_b16 v[48:49], v25 offset:0
    ds_read_b64_tr_b16 v[50:51], v25 offset:256
    ds_read_b128 v[36:39], v15 offset:0
    ds_read_b128 v[40:43], v15 offset:4096
    ds_read_b64_tr_b16 v[52:53], v24 offset:1024
    ds_read_b64_tr_b16 v[54:55], v24 offset:1280
    ds_read_b64_tr_b16 v[56:57], v25 offset:1024
    ds_read_b64_tr_b16 v[58:59], v25 offset:1280
    s_waitcnt lgkmcnt(6)
    v_mfma_f32_32x32x16_bf16 v[60:75], v[28:31], v[44:47], v[60:75]
    s_add_u32 s62, s62, 1
    s_cmp_eq_u32 s62, 10
    s_cselect_b32 s63, 4294966016, 0
    s_cselect_b32 s64, 4292509696, 0
    s_cselect_b32 s62, 0, s62
    s_add_u32 s63, s63, 128
    s_add_u32 s64, s64, 245760
    s_add_u32 m0, s46, 0
    s_nop 0
    buffer_load_dwordx4 v1, s[28:31], s40 offen lds
    s_add_u32 s40, s40, s63
    v_mfma_f32_32x32x16_bf16 v[76:91], v[28:31], v[48:51], v[76:91]
    v_mfma_f32_32x32x16_bf16 v[92:107], v[32:35], v[44:47], v[92:107]
    s_add_u32 m0, s47, 0
    s_nop 0
    buffer_load_dwordx4 v2, s[28:31], s41 offen lds
    s_add_u32 s41, s41, s63
    v_mfma_f32_32x32x16_bf16 v[108:123], v[32:35], v[48:51], v[108:123]
    ds_read_b128 v[28:31], v16 offset:0
    ds_read_b128 v[32:35], v16 offset:4096
    ds_read_b64_tr_b16 v[44:45], v24 offset:2048
    ds_read_b64_tr_b16 v[46:47], v24 offset:2304
    ds_read_b64_tr_b16 v[48:49], v25 offset:2048
    ds_read_b64_tr_b16 v[50:51], v25 offset:2304
    s_waitcnt lgkmcnt(6)
    v_mfma_f32_32x32x16_bf16 v[60:75], v[36:39], v[52:55], v[60:75]
    v_mfma_f32_32x32x16_bf16 v[76:91], v[36:39], v[56:59], v[76:91]
    s_add_u32 m0, s48, 0
    s_nop 0
    buffer_load_dwordx4 v1, s[28:31], s42 offen lds
    s_add_u32 s42, s42, s63
    v_mfma_f32_32x32x16_bf16 v[92:107], v[40:43], v[52:55], v[92:107]
    v_mfma_f32_32x32x16_bf16 v[108:123], v[40:43], v[56:59], v[108:123]
    ds_read_b128 v[36:39], v17 offset:0
    ds_read_b128 v[40:43], v17 offset:4096
    ds_read_b64_tr_b16 v[52:53], v24 offset:3072
    ds_read_b64_tr_b16 v[54:55], v24 offset:3328
    ds_read_b64_tr_b16 v[56:57], v25 offset:3072
    ds_read_b64_tr_b16 v[58:59], v25 offset:3328
    s_waitcnt lgkmcnt(6)
    v_mfma_f32_32x32x16_bf16 v[60:75], v[28:31], v[44:47], v[60:75]
    s_add_u32 m0, s49, 0
    s_nop 0
    buffer_load_dwordx4 v2, s[28:31], s43 offen lds
    s_add_u32 s43, s43, s63
    v_mfma_f32_32x32x16_bf16 v[76:91], v[28:31], v[48:51], v[76:91]
    v_mfma_f32_32x32x16_bf16 v[92:107], v[32:35], v[44:47], v[92:107]
    s_add_u32 m0, s50, 0
    s_nop 0
    buffer_load_dwordx4 v3, s[32:35], s44 offen lds
    s_add_u32 s44, s44, s64
    v_mfma_f32_32x32x16_bf16 v[108:123], v[32:35], v[48:51], v[108:123]
    s_waitcnt lgkmcnt(0)
    v_mfma_f32_32x32x16_bf16 v[60:75], v[36:39], v[52:55], v[60:75]
    v_mfma_f32_32x32x16_bf16 v[76:91], v[36:39], v[56:59], v[76:91]
    s_add_u32 m0, s51, 0
    s_nop 0
    buffer_load_dwordx4 v3, s[32:35], s45 offen lds
    s_add_u32 s45, s45, s64
    v_mfma_f32_32x32x16_bf16 v[92:107], v[40:43], v[52:55], v[92:107]
    v_mfma_f32_32x32x16_bf16 v[108:123], v[40:43], v[56:59], v[108:123]
    s_waitcnt vmcnt(6)
    s_barrier
    ds_read_b128 v[28:31], v18 offset:0
    ds_read_b128 v[32:35], v18 offset:4096
    ds_read_b64_tr_b16 v[44:45], v26 offset:0
    ds_read_b64_tr_b16 v[46:47], v26 offset:256
    ds_read_b64_tr_b16 v[48:49], v27 offset:0
    ds_read_b64_tr_b16 v[50:51], v27 offset:256
    ds_read_b128 v[36:39], v19 offset:0
    ds_read_b128 v[40:43], v19 offset:4096
    ds_read_b64_tr_b16 v[52:53], v26 offset:1024
    ds_read_b64_tr_b16 v[54:55], v26 offset:1280
    ds_read_b64_tr_b16 v[56:57], v27 offset:1024
    ds_read_b64_tr_b16 v[58:59], v27 offset:1280
    s_waitcnt lgkmcnt(6)
    v_mfma_f32_32x32x16_bf16 v[60:75], v[28:31], v[44:47], v[60:75]
    v_mfma_f32_32x32x16_bf16 v[76:91], v[28:31], v[48:51], v[76:91]
    v_mfma_f32_32x32x16_bf16 v[92:107], v[32:35], v[44:47], v[92:107]
    v_mfma_f32_32x32x16_bf16 v[108:123], v[32:35], v[48:51], v[108:123]
    ds_read_b128 v[28:31], v20 offset:0
    ds_read_b128 v[32:35], v20 offset:4096
    ds_read_b64_tr_b16 v[44:45], v26 offset:2048
    ds_read_b64_tr_b16 v[46:47], v26 offset:2304
    ds_read_b64_tr_b16 v[48:49], v27 offset:2048
    ds_read_b64_tr_b16 v[50:51], v27 offset:2304
    s_waitcnt lgkmcnt(6)
    v_mfma_f32_32x32x16_bf16 v[60:75], v[36:39], v[52:55], v[60:75]
    v_mfma_f32_32x32x16_bf16 v[76:91], v[36:39], v[56:59], v[76:91]
    v_mfma_f32_32x32x16_bf16 v[92:107], v[40:43], v[52:55], v[92:107]
    v_mfma_f32_32x32x16_bf16 v[108:123], v[40:43], v[56:59], v[108:123]
    ds_read_b128 v[36:39], v21 offset:0
    ds_read_b128 v[40:43], v21 offset:4096
    ds_read_b64_tr_b16 v[52:53], v26 offset:3072
    ds_read_b64_tr_b16 v[54:55], v26 offset:3328
    ds_read_b64_tr_b16 v[56:57], v27 offset:3072
    ds_read_b64_tr_b16 v[58:59], v27 offset:3328
    s_waitcnt lgkmcnt(6)
    v_mfma_f32_32x32x16_bf16 v[60:75], v[28:31], v[44:47], v[60:75]
    v_mfma_f32_32x32x16_bf16 v[76:91], v[28:31], v[48:51], v[76:91]
    v_mfma_f32_32x32x16_bf16 v[92:107], v[32:35], v[44:47], v[92:107]
    v_mfma_f32_32x32x16_bf16 v[108:123], v[32:35], v[48:51], v[108:123]
    s_waitcnt lgkmcnt(0)
    v_mfma_f32_32x32x16_bf16 v[60:75], v[36:39], v[52:55], v[60:75]
    v_mfma_f32_32x32x16_bf16 v[76:91], v[36:39], v[56:59], v[76:91]
    v_mfma_f32_32x32x16_bf16 v[92:107], v[40:43], v[52:55], v[92:107]
    v_mfma_f32_32x32x16_bf16 v[108:123], v[40:43], v[56:59], v[108:123]
    s_waitcnt vmcnt(0)
    s_barrier
    ds_read_b128 v[28:31], v10 offset:0
    ds_read_b128 v[32:35], v10 offset:4096
    ds_read_b64_tr_b16 v[44:45], v22 offset:0
    ds_read_b64_tr_b16 v[46:47], v22 offset:256
    ds_read_b64_tr_b16 v[48:49], v23 offset:0
    ds_read_b64_tr_b16 v[50:51], v23 offset:256
    ds_read_b128 v[36:39], v11 offset:0
    ds_read_b128 v[40:43], v11 offset:4096
    ds_read_b64_tr_b16 v[52:53], v22 offset:1024
    ds_read_b64_tr_b16 v[54:55], v22 offset:1280
    ds_read_b64_tr_b16 v[56:57], v23 offset:1024
    ds_read_b64_tr_b16 v[58:59], v23 offset:1280
    s_waitcnt lgkmcnt(6)
    v_mfma_f32_32x32x16_bf16 v[60:75], v[28:31], v[44:47], v[60:75]
    v_mfma_f32_32x32x16_bf16 v[76:91], v[28:31], v[48:51], v[76:91]
    v_mfma_f32_32x32x16_bf16 v[92:107], v[32:35], v[44:47], v[92:107]
    v_mfma_f32_32x32x16_bf16 v[108:123], v[32:35], v[48:51], v[108:123]
    ds_read_b128 v[28:31], v12 offset:0
    ds_read_b128 v[32:35], v12 offset:4096
    ds_read_b64_tr_b16 v[44:45], v22 offset:2048
    ds_read_b64_tr_b16 v[46:47], v22 offset:2304
    ds_read_b64_tr_b16 v[48:49], v23 offset:2048
    ds_read_b64_tr_b16 v[50:51], v23 offset:2304
    s_waitcnt lgkmcnt(6)
    v_mfma_f32_32x32x16_bf16 v[60:75], v[36:39], v[52:55], v[60:75]
    v_mfma_f32_32x32x16_bf16 v[76:91], v[36:39], v[56:59], v[76:91]
    v_mfma_f32_32x32x16_bf16 v[92:107], v[40:43], v[52:55], v[92:107]
    v_mfma_f32_32x32x16_bf16 v[108:123], v[40:43], v[56:59], v[108:123]
    ds_read_b128 v[36:39], v13 offset:0
    ds_read_b128 v[40:43], v13 offset:4096
    ds_read_b64_tr_b16 v[52:53], v22 offset:3072
    ds_read_b64_tr_b16 v[54:55], v22 offset:3328
    ds_read_b64_tr_b16 v[56:57], v23 offset:3072
    ds_read_b64_tr_b16 v[58:59], v23 offset:3328
    s_waitcnt lgkmcnt(6)
    v_mfma_f32_32x32x16_bf16 v[60:75], v[28:31], v[44:47], v[60:75]
    v_mfma_f32_32x32x16_bf16 v[76:91], v[28:31], v[48:51], v[76:91]
    v_mfma_f32_32x32x16_bf16 v[92:107], v[32:35], v[44:47], v[92:107]
    v_mfma_f32_32x32x16_bf16 v[108:123], v[32:35], v[48:51], v[108:123]
    s_waitcnt lgkmcnt(0)
    v_mfma_f32_32x32x16_bf16 v[60:75], v[36:39], v[52:55], v[60:75]
    v_mfma_f32_32x32x16_bf16 v[76:91], v[36:39], v[56:59], v[76:91]
    v_mfma_f32_32x32x16_bf16 v[92:107], v[40:43], v[52:55], v[92:107]
    v_mfma_f32_32x32x16_bf16 v[108:123], v[40:43], v[56:59], v[108:123]
    s_nop 15
    s_sub_u32 s52, s24, 10
    s_lshl_b32 s52, s52, 7
    s_lshl_b32 s53, s55, 6
    s_add_u32 s52, s52, s53
    s_mul_i32 s53, s23, 4
    s_add_u32 s53, s53, s54
    s_mul_i32 s53, s53, 3072
    s_add_u32 s56, s53, 6291456
    s_mov_b32 s58, 98304
    v_and_b32 v4, 31, v0
    v_add_u32 v4, s52, v4
    v_lshrrev_b32 v5, 5, v0
    v_mul_u32_u24 v5, 384, v5
    v_add_u32 v6, 0, v4
    v_mul_u32_u24 v7, 3277, v6
    v_lshrrev_b32 v7, 16, v7
    v_mul_u32_u24 v8, 20, v7
    v_sub_u32 v6, v6, v8
    v_mul_lo_u32 v7, v7, s58
    v_add_u32 v7, v7, v5
    v_lshl_add_u32 v7, v6, 4, v7
    v_cmp_eq_u32 vcc, 16, v6
    v_mov_b32 v9, 0x3f803f80
    s_nop 1
    v_cndmask_b32 v140, 0, v9, vcc
    v_mov_b32 v141, v140
    v_mov_b32 v142, v140
    v_mov_b32 v143, v140
    v_cmp_le_u32 vcc, 16, v6
    v_cvt_pk_bf16_f32 v124, v60, v61
    v_cvt_pk_bf16_f32 v125, v62, v63
    v_cvt_pk_bf16_f32 v126, v64, v65
    v_cvt_pk_bf16_f32 v127, v66, v67
    buffer_store_dwordx4 v[124:127], v7, s[36:39], s56 offen offset:0
    v_cvt_pk_bf16_f32 v128, v68, v69
    v_cvt_pk_bf16_f32 v129, v70, v71
    v_cvt_pk_bf16_f32 v130, v72, v73
    v_cvt_pk_bf16_f32 v131, v74, v75
    buffer_store_dwordx4 v[128:131], v7, s[36:39], s56 offen offset:768
    v_cvt_pk_bf16_f32 v132, v92, v93
    v_cvt_pk_bf16_f32 v133, v94, v95
    v_cvt_pk_bf16_f32 v134, v96, v97
    v_cvt_pk_bf16_f32 v135, v98, v99
    buffer_store_dwordx4 v[132:135], v7, s[36:39], s56 offen offset:1536
    v_cvt_pk_bf16_f32 v136, v100, v101
    v_cvt_pk_bf16_f32 v137, v102, v103
    v_cvt_pk_bf16_f32 v138, v104, v105
    v_cvt_pk_bf16_f32 v139, v106, v107
    buffer_store_dwordx4 v[136:139], v7, s[36:39], s56 offen offset:2304
    s_and_saveexec_b64 s[60:61], vcc
    buffer_store_dwordx4 v[140:143], v7, s[36:39], s56 offen offset:64
    buffer_store_dwordx4 v[140:143], v7, s[36:39], s56 offen offset:832
    buffer_store_dwordx4 v[140:143], v7, s[36:39], s56 offen offset:1600
    buffer_store_dwordx4 v[140:143], v7, s[36:39], s56 offen offset:2368
    s_mov_b64 exec, s[60:61]
    v_add_u32 v6, 32, v4
    v_mul_u32_u24 v7, 3277, v6
    v_lshrrev_b32 v7, 16, v7
    v_mul_u32_u24 v8, 20, v7
    v_sub_u32 v6, v6, v8
    v_mul_lo_u32 v7, v7, s58
    v_add_u32 v7, v7, v5
    v_lshl_add_u32 v7, v6, 4, v7
    v_cmp_eq_u32 vcc, 16, v6
    v_mov_b32 v9, 0x3f803f80
    s_nop 1
    v_cndmask_b32 v140, 0, v9, vcc
    v_mov_b32 v141, v140
    v_mov_b32 v142, v140
    v_mov_b32 v143, v140
    v_cmp_le_u32 vcc, 16, v6
    v_cvt_pk_bf16_f32 v124, v76, v77
    v_cvt_pk_bf16_f32 v125, v78, v79
    v_cvt_pk_bf16_f32 v126, v80, v81
    v_cvt_pk_bf16_f32 v127, v82, v83
    buffer_store_dwordx4 v[124:127], v7, s[36:39], s56 offen offset:0
    v_cvt_pk_bf16_f32 v128, v84, v85
    v_cvt_pk_bf16_f32 v129, v86, v87
    v_cvt_pk_bf16_f32 v130, v88, v89
    v_cvt_pk_bf16_f32 v131, v90, v91
    buffer_store_dwordx4 v[128:131], v7, s[36:39], s56 offen offset:768
    v_cvt_pk_bf16_f32 v132, v108, v109
    v_cvt_pk_bf16_f32 v133, v110, v111
    v_cvt_pk_bf16_f32 v134, v112, v113
    v_cvt_pk_bf16_f32 v135, v114, v115
    buffer_store_dwordx4 v[132:135], v7, s[36:39], s56 offen offset:1536
    v_cvt_pk_bf16_f32 v136, v116, v117
    v_cvt_pk_bf16_f32 v137, v118, v119
    v_cvt_pk_bf16_f32 v138, v120, v121
    v_cvt_pk_bf16_f32 v139, v122, v123
    buffer_store_dwordx4 v[136:139], v7, s[36:39], s56 offen offset:2304
    s_and_saveexec_b64 s[60:61], vcc
    buffer_store_dwordx4 v[140:143], v7, s[36:39], s56 offen offset:64
    buffer_store_dwordx4 v[140:143], v7, s[36:39], s56 offen offset:832
    buffer_store_dwordx4 v[140:143], v7, s[36:39], s56 offen offset:1600
    buffer_store_dwordx4 v[140:143], v7, s[36:39], s56 offen offset:2368
    s_mov_b64 exec, s[60:61]
qkv_end:
    s_endpgm
.p2align 8
.globl att_kernel
.type att_kernel,@function
att_kernel:
    s_cmp_ge_u32 s2, 256
    s_cbranch_scc1 att_end
    s_load_dwordx2 s[20:21], s[0:1], 64
    s_load_dwordx2 s[4:5], s[0:1], 16
    s_load_dwordx2 s[6:7], s[0:1], 40
    v_lshrrev_b32 v1, 6, v0
    v_and_b32 v0, 63, v0
    v_readfirstlane_b32 s25, v1
    s_mov_b32 s50, -1
    s_mov_b32 s51, 0
    s_mov_b32 s52, 0x00ffffff
    s_mov_b32 s53, 0x00ffffff
    v_lshlrev_b32 v1, 4, v0
    v_and_b32 v3, 31, v0
    v_lshrrev_b32 v4, 5, v0
    v_mul_u32_u24 v2, 384, v4
    v_lshl_add_u32 v2, v3, 4, v2
    s_waitcnt lgkmcnt(0)
    s_and_b32 s21, s21, 0xffff
    v_mov_b32 v12, 0
    v_mov_b32 v13, 0
    v_mov_b32 v14, 0
    v_mov_b32 v15, 0
    v_mov_b32 v16, 0
    v_mov_b32 v17, 0
    v_mov_b32 v18, 0
    v_mov_b32 v19, 0
    v_mov_b32 v116, 0
    v_mov_b32 v117, 0
    v_mov_b32 v118, 0
    v_mov_b32 v119, 0
    v_mov_b32 v120, 0
    v_mov_b32 v121, 0
    v_mov_b32 v122, 0
    v_mov_b32 v123, 0
    v_mov_b32 v20, 0
    v_mov_b32 v21, 0
    v_mov_b32 v22, 0
    v_mov_b32 v23, 0
    v_mov_b32 v24, 0
    v_mov_b32 v25, 0
    v_mov_b32 v26, 0
    v_mov_b32 v27, 0
    v_mov_b32 v28, 0
    v_mov_b32 v29, 0
    v_mov_b32 v30, 0
    v_mov_b32 v31, 0
    v_mov_b32 v32, 0
    v_mov_b32 v33, 0
    v_mov_b32 v34, 0
    v_mov_b32 v35, 0
    v_mov_b32 v36, 0
    v_mov_b32 v37, 0
    v_mov_b32 v38, 0
    v_mov_b32 v39, 0
    v_mov_b32 v40, 0
    v_mov_b32 v41, 0
    v_mov_b32 v42, 0
    v_mov_b32 v43, 0
    v_mov_b32 v44, 0
    v_mov_b32 v45, 0
    v_mov_b32 v46, 0
    v_mov_b32 v47, 0
    v_mov_b32 v48, 0
    v_mov_b32 v49, 0
    v_mov_b32 v50, 0
    v_mov_b32 v51, 0
    s_add_u32 s28, s20, 16777216
    s_addc_u32 s29, s21, 0
    s_mov_b32 s30, 3145728
    s_mov_b32 s31, 0x00020000
    s_add_u32 s32, s20, 19922944
    s_addc_u32 s33, s21, 0
    s_mov_b32 s34, 3145728
    s_mov_b32 s35, 0x00020000
    s_add_u32 s36, s20, 23068672
    s_addc_u32 s37, s21, 0
    s_mov_b32 s38, 3145728
    s_mov_b32 s39, 0x00020000
    s_add_u32 s40, s20, 26214400
    s_addc_u32 s41, s21, 0
    s_mov_b32 s42, 2621440
    s_mov_b32 s43, 0x00020000
    s_and_b32 s26, s2, 7
    s_lshr_b32 s27, s2, 3
    s_lshl_b32 s22, s26, 2
    s_and_b32 s26, s27, 3
    s_add_u32 s22, s22, s26
    s_lshr_b32 s27, s27, 2
    s_mul_i32 s23, s27, 8
    s_add_u32 s23, s23, s25
    s_lshl_b32 s26, s22, 6
    s_add_u32 s26, s26, s23
    s_mul_i32 s54, s26, 1536
    buffer_load_dwordx4 v[116:119], v1, s[28:31], s54 offen
    s_mov_b64 exec, s[50:51]
    buffer_load_dwordx2 v[120:121], v1, s[28:31], s54 offen offset:1024
    s_mov_b64 exec, -1
    s_cmp_ge_u32 s25, 4
    s_cselect_b32 s44, s36, s32
    s_cselect_b32 s45, s37, s33
    s_cselect_b32 s46, s38, s34
    s_cselect_b32 s47, s39, s35
    s_and_b32 s26, s25, 3
    s_mul_i32 s26, s26, 3072
    s_mul_i32 s48, s22, 98304
    s_add_u32 s48, s48, s26
    s_mul_i32 s49, s25, 3072
    s_mov_b32 s56, 0
    s_add_u32 m0, s49, s56
    s_add_u32 s56, s56, 24576
    buffer_load_dwordx4 v1, s[44:47], s48 offen offset:0 lds
    buffer_load_dwordx4 v1, s[44:47], s48 offen offset:1024 lds
    buffer_load_dwordx4 v1, s[44:47], s48 offen offset:2048 lds
    s_cmp_ge_u32 s56, 73728
    s_cselect_b32 s56, 0, s56
    s_add_u32 s48, s48, 12288
    s_add_u32 m0, s49, s56
    s_add_u32 s56, s56, 24576
    buffer_load_dwordx4 v1, s[44:47], s48 offen offset:0 lds
    buffer_load_dwordx4 v1, s[44:47], s48 offen offset:1024 lds
    buffer_load_dwordx4 v1, s[44:47], s48 offen offset:2048 lds
    s_cmp_ge_u32 s56, 73728
    s_cselect_b32 s56, 0, s56
    s_add_u32 s48, s48, 12288
    s_add_u32 s28, s20, 0
    s_addc_u32 s29, s21, 0
    s_mov_b32 s30, 3145728
    s_mov_b32 s31, 0x00020000
    s_add_u32 s32, s20, 3145728
    s_addc_u32 s33, s21, 0
    s_mov_b32 s34, 3145728
    s_mov_b32 s35, 0x00020000
    s_add_u32 s36, s20, 6291456
    s_addc_u32 s37, s21, 0
    s_mov_b32 s38, 3145728
    s_mov_b32 s39, 0x00020000
    s_add_u32 s40, s20, 9437184
    s_addc_u32 s41, s21, 0
    s_mov_b32 s42, 2621440
    s_mov_b32 s43, 0x00020000
    s_mul_i32 s26, s2, 8
    s_add_u32 s26, s26, s25
    s_lshr_b32 s17, s26, 6
    s_and_b32 s18, s26, 63
    s_mul_i32 s54, s26, 1536
    s_sub_u32 s55, s54, 1536
    s_cmp_eq_u32 s18, 0
    s_cselect_b32 s55, s54, s55
    s_cselect_b32 s19, 0, -1
    v_mov_b32 v128, 0
    v_mov_b32 v129, 0
    v_mov_b32 v130, 0
    v_mov_b32 v131, 0
    v_mov_b32 v132, 0
    v_mov_b32 v133, 0
    v_mov_b32 v134, 0
    v_mov_b32 v135, 0
    v_mov_b32 v136, 0
    v_mov_b32 v137, 0
    v_mov_b32 v138, 0
    v_mov_b32 v139, 0
    v_mov_b32 v140, 0
    v_mov_b32 v141, 0
    v_mov_b32 v142, 0
    v_mov_b32 v143, 0
    v_mov_b32 v144, 0
    v_mov_b32 v145, 0
    v_mov_b32 v146, 0
    v_mov_b32 v147, 0
    v_mov_b32 v148, 0
    v_mov_b32 v149, 0
    v_mov_b32 v150, 0
    v_mov_b32 v151, 0
    v_mov_b32 v152, 0
    v_mov_b32 v153, 0
    v_mov_b32 v154, 0
    v_mov_b32 v155, 0
    v_mov_b32 v156, 0
    v_mov_b32 v157, 0
    v_mov_b32 v158, 0
    v_mov_b32 v159, 0
    v_mov_b32 v160, 0
    v_mov_b32 v161, 0
    v_mov_b32 v162, 0
    v_mov_b32 v163, 0
    v_mov_b32 v164, 0
    v_mov_b32 v165, 0
    v_mov_b32 v166, 0
    v_mov_b32 v167, 0
    buffer_load_dwordx4 v[128:131], v1, s[28:31], s54 offen
    s_mov_b64 exec, s[50:51]
    buffer_load_dwordx2 v[132:133], v1, s[28:31], s54 offen offset:1024
    s_mov_b64 exec, -1
    buffer_load_dwordx4 v[136:139], v1, s[32:35], s55 offen
    s_mov_b64 exec, s[50:51]
    buffer_load_dwordx4 v[140:143], v1, s[32:35], s55 offen offset:1024
    s_mov_b64 exec, s[52:53]
    buffer_load_dwordx4 v[152:155], v2, s[36:39], s55 offen
    buffer_load_dwordx4 v[156:159], v2, s[36:39], s55 offen offset:768
    s_mov_b64 exec, -1
    buffer_load_dwordx4 v[144:147], v1, s[32:35], s54 offen
    s_mov_b64 exec, s[50:51]
    buffer_load_dwordx4 v[148:151], v1, s[32:35], s54 offen offset:1024
    s_mov_b64 exec, s[52:53]
    buffer_load_dwordx4 v[160:163], v2, s[36:39], s54 offen
    buffer_load_dwordx4 v[164:167], v2, s[36:39], s54 offen offset:768
    s_mov_b64 exec, -1
    s_mov_b32 s76, s40
    s_mov_b32 s77, s41
    s_mov_b32 s78, s42
    s_mov_b32 s79, s43
    s_add_u32 s28, s20, 16777216
    s_addc_u32 s29, s21, 0
    s_mov_b32 s30, 3145728
    s_mov_b32 s31, 0x00020000
    s_add_u32 s32, s20, 19922944
    s_addc_u32 s33, s21, 0
    s_mov_b32 s34, 3145728
    s_mov_b32 s35, 0x00020000
    s_add_u32 s36, s20, 23068672
    s_addc_u32 s37, s21, 0
    s_mov_b32 s38, 3145728
    s_mov_b32 s39, 0x00020000
    s_add_u32 s40, s20, 26214400
    s_addc_u32 s41, s21, 0
    s_mov_b32 s42, 2621440
    s_mov_b32 s43, 0x00020000
    v_mov_b32 v92, 0
    v_mov_b32 v93, 0
    v_mov_b32 v94, 0
    v_mov_b32 v95, 0
    v_mov_b32 v96, 0
    v_mov_b32 v97, 0
    v_mov_b32 v98, 0
    v_mov_b32 v99, 0
    v_mov_b32 v100, 0
    v_mov_b32 v101, 0
    v_mov_b32 v102, 0
    v_mov_b32 v103, 0
    v_mov_b32 v104, 0
    v_mov_b32 v105, 0
    v_mov_b32 v106, 0
    v_mov_b32 v107, 0
    v_mov_b32 v10, v1
    v_add_u32 v11, 24576, v1
    v_add_u32 v124, 12288, v2
    s_mov_b32 s57, 24576
    s_waitcnt vmcnt(13)
    v_mov_b32 v12, v116
    v_mov_b32 v13, v117
    v_mov_b32 v14, v118
    v_mov_b32 v15, v119
    v_mov_b32 v16, v120
    v_mov_b32 v17, v121
    v_mov_b32 v18, v122
    v_mov_b32 v19, v123
    s_barrier
    ds_read_b128 v[20:23], v10 offset:0
    s_mov_b64 exec, s[50:51]
    ds_read_b128 v[24:27], v10 offset:1024
    s_mov_b64 exec, -1
    s_waitcnt lgkmcnt(0)
    v_mfma_f32_32x32x16_bf16 v[52:67], v[20:23], v[12:15], 0
    v_mfma_f32_32x32x16_bf16 v[52:67], v[24:27], v[16:19], v[52:67]
    s_nop 15
    v_max3_f32 v108, v52, v53, v54
    v_max3_f32 v108, v108, v55, v56
    v_max3_f32 v108, v108, v57, v58
    v_max3_f32 v108, v108, v59, v60
    v_max3_f32 v108, v108, v61, v62
    v_max3_f32 v108, v108, v63, v64
    v_max3_f32 v108, v108, v65, v66
    v_max_f32 v108, v108, v67
    v_mov_b32 v3, v108
    s_nop 1
    v_permlane32_swap_b32 v108, v3
    v_max_f32 v108, v108, v3
    v_sub_f32 v108, 0, v108
    s_mov_b64 exec, s[50:51]
    v_cvt_pk_bf16_f32 v18, v108, 0
    s_mov_b64 exec, -1
    ds_read_b128 v[28:31], v10 offset:1536
    s_mov_b64 exec, s[50:51]
    ds_read_b128 v[32:35], v10 offset:2560
    s_mov_b64 exec, -1
    s_nop 1
    v_mfma_f32_32x32x16_bf16 v[52:67], v[20:23], v[12:15], 0
    v_mfma_f32_32x32x16_bf16 v[52:67], v[24:27], v[16:19], v[52:67]
    s_mov_b32 s24, 0
att_loop:
    ds_read_b128 v[20:23], v10 offset:3072
    s_mov_b64 exec, s[50:51]
    ds_read_b128 v[24:27], v10 offset:4096
    s_mov_b64 exec, s[52:53]
    ds_read_b128 v[36:39], v124 offset:0
    ds_read_b128 v[40:43], v124 offset:768
    s_mov_b64 exec, -1
    s_waitcnt lgkmcnt(4)
    v_mfma_f32_32x32x16_bf16 v[68:83], v[28:31], v[12:15], 0
    v_exp_f32 v52, v52
    v_exp_f32 v53, v53
    v_exp_f32 v54, v54
    v_exp_f32 v55, v55
    v_exp_f32 v56, v56
    v_exp_f32 v57, v57
    v_exp_f32 v58, v58
    v_exp_f32 v59, v59
    v_mfma_f32_32x32x16_bf16 v[68:83], v[32:35], v[16:19], v[68:83]
    v_cvt_pk_bf16_f32 v84, v52, v53
    v_cvt_pk_bf16_f32 v85, v54, v55
    v_cvt_pk_bf16_f32 v86, v56, v57
    v_cvt_pk_bf16_f32 v87, v58, v59
    v_exp_f32 v60, v60
    v_exp_f32 v61, v61
    v_exp_f32 v62, v62
    v_exp_f32 v63, v63
    v_exp_f32 v64, v64
    v_exp_f32 v65, v65
    v_exp_f32 v66, v66
    v_exp_f32 v67, v67
    s_waitcnt lgkmcnt(0)
    v_mfma_f32_32x32x16_bf16 v[92:107], v[36:39], v[84:87], v[92:107]
    v_cvt_pk_bf16_f32 v88, v60, v61
    v_cvt_pk_bf16_f32 v89, v62, v63
    v_cvt_pk_bf16_f32 v90, v64, v65
    v_cvt_pk_bf16_f32 v91, v66, v67
    s_nop 1
    v_mfma_f32_32x32x16_bf16 v[92:107], v[40:43], v[88:91], v[92:107]
    ds_read_b128 v[28:31], v10 offset:4608
    s_mov_b64 exec, s[50:51]
    ds_read_b128 v[32:35], v10 offset:5632
    s_mov_b64 exec, s[52:53]
    ds_read_b128 v[44:47], v124 offset:1536
    ds_read_b128 v[48:51], v124 offset:2304
    s_mov_b64 exec, -1
    s_waitcnt lgkmcnt(4)
    v_mfma_f32_32x32x16_bf16 v[52:67], v[20:23], v[12:15], 0
    v_exp_f32 v68, v68
    v_exp_f32 v69, v69
    v_exp_f32 v70, v70
    v_exp_f32 v71, v71
    v_exp_f32 v72, v72
    v_exp_f32 v73, v73
    v_exp_f32 v74, v74
    v_exp_f32 v75, v75
    v_mfma_f32_32x32x16_bf16 v[52:67], v[24:27], v[16:19], v[52:67]
    v_cvt_pk_bf16_f32 v84, v68, v69
    v_cvt_pk_bf16_f32 v85, v70, v71
    v_cvt_pk_bf16_f32 v86, v72, v73
    v_cvt_pk_bf16_f32 v87, v74, v75
    v_exp_f32 v76, v76
    v_exp_f32 v77, v77
    v_exp_f32 v78, v78
    v_exp_f32 v79, v79
    v_exp_f32 v80, v80
    v_exp_f32 v81, v81
    v_exp_f32 v82, v82
    v_exp_f32 v83, v83
    s_waitcnt lgkmcnt(0)
    v_mfma_f32_32x32x16_bf16 v[92:107], v[44:47], v[84:87], v[92:107]
    v_cvt_pk_bf16_f32 v88, v76, v77
    v_cvt_pk_bf16_f32 v89, v78, v79
    v_cvt_pk_bf16_f32 v90, v80, v81
    v_cvt_pk_bf16_f32 v91, v82, v83
    s_nop 1
    v_mfma_f32_32x32x16_bf16 v[92:107], v[48:51], v[88:91], v[92:107]
    ds_read_b128 v[20:23], v10 offset:6144
    s_mov_b64 exec, s[50:51]
    ds_read_b128 v[24:27], v10 offset:7168
    s_mov_b64 exec, s[52:53]
    ds_read_b128 v[36:39], v124 offset:3072
    ds_read_b128 v[40:43], v124 offset:3840
    s_mov_b64 exec, -1
    s_waitcnt lgkmcnt(4)
    v_mfma_f32_32x32x16_bf16 v[68:83], v[28:31], v[12:15], 0
    v_exp_f32 v52, v52
    v_exp_f32 v53, v53
    v_exp_f32 v54, v54
    v_exp_f32 v55, v55
    v_exp_f32 v56, v56
    v_exp_f32 v57, v57
    v_exp_f32 v58, v58
    v_exp_f32 v59, v59
    v_mfma_f32_32x32x16_bf16 v[68:83], v[32:35], v[16:19], v[68:83]
    v_cvt_pk_bf16_f32 v84, v52, v53
    v_cvt_pk_bf16_f32 v85, v54, v55
    v_cvt_pk_bf16_f32 v86, v56, v57
    v_cvt_pk_bf16_f32 v87, v58, v59
    v_exp_f32 v60, v60
    v_exp_f32 v61, v61
    v_exp_f32 v62, v62
    v_exp_f32 v63, v63
    v_exp_f32 v64, v64
    v_exp_f32 v65, v65
    v_exp_f32 v66, v66
    v_exp_f32 v67, v67
    s_waitcnt lgkmcnt(0)
    v_mfma_f32_32x32x16_bf16 v[92:107], v[36:39], v[84:87], v[92:107]
    v_cvt_pk_bf16_f32 v88, v60, v61
    v_cvt_pk_bf16_f32 v89, v62, v63
    v_cvt_pk_bf16_f32 v90, v64, v65
    v_cvt_pk_bf16_f32 v91, v66, v67
    s_nop 1
    v_mfma_f32_32x32x16_bf16 v[92:107], v[40:43], v[88:91], v[92:107]
    ds_read_b128 v[28:31], v10 offset:7680
    s_mov_b64 exec, s[50:51]
    ds_read_b128 v[32:35], v10 offset:8704
    s_mov_b64 exec, s[52:53]
    ds_read_b128 v[44:47], v124 offset:4608
    ds_read_b128 v[48:51], v124 offset:5376
    s_mov_b64 exec, -1
    s_waitcnt lgkmcnt(4)
    v_mfma_f32_32x32x16_bf16 v[52:67], v[20:23], v[12:15], 0
    v_exp_f32 v68, v68
    v_exp_f32 v69, v69
    v_exp_f32 v70, v70
    v_exp_f32 v71, v71
    v_exp_f32 v72, v72
    v_exp_f32 v73, v73
    v_exp_f32 v74, v74
    v_exp_f32 v75, v75
    v_mfma_f32_32x32x16_bf16 v[52:67], v[24:27], v[16:19], v[52:67]
    v_cvt_pk_bf16_f32 v84, v68, v69
    v_cvt_pk_bf16_f32 v85, v70, v71
    v_cvt_pk_bf16_f32 v86, v72, v73
    v_cvt_pk_bf16_f32 v87, v74, v75
    v_exp_f32 v76, v76
    v_exp_f32 v77, v77
    v_exp_f32 v78, v78
    v_exp_f32 v79, v79
    v_exp_f32 v80, v80
    v_exp_f32 v81, v81
    v_exp_f32 v82, v82
    v_exp_f32 v83, v83
    s_waitcnt lgkmcnt(0)
    v_mfma_f32_32x32x16_bf16 v[92:107], v[44:47], v[84:87], v[92:107]
    v_cvt_pk_bf16_f32 v88, v76, v77
    v_cvt_pk_bf16_f32 v89, v78, v79
    v_cvt_pk_bf16_f32 v90, v80, v81
    v_cvt_pk_bf16_f32 v91, v82, v83
    s_nop 1
    v_mfma_f32_32x32x16_bf16 v[92:107], v[48:51], v[88:91], v[92:107]
    ds_read_b128 v[20:23], v10 offset:9216
    s_mov_b64 exec, s[50:51]
    ds_read_b128 v[24:27], v10 offset:10240
    s_mov_b64 exec, s[52:53]
    ds_read_b128 v[36:39], v124 offset:6144
    ds_read_b128 v[40:43], v124 offset:6912
    s_mov_b64 exec, -1
    s_waitcnt lgkmcnt(4)
    v_mfma_f32_32x32x16_bf16 v[68:83], v[28:31], v[12:15], 0
    v_exp_f32 v52, v52
    v_exp_f32 v53, v53
    v_exp_f32 v54, v54
    v_exp_f32 v55, v55
    v_exp_f32 v56, v56
    v_exp_f32 v57, v57
    v_exp_f32 v58, v58
    v_exp_f32 v59, v59
    v_mfma_f32_32x32x16_bf16 v[68:83], v[32:35], v[16:19], v[68:83]
    v_cvt_pk_bf16_f32 v84, v52, v53
    v_cvt_pk_bf16_f32 v85, v54, v55
    v_cvt_pk_bf16_f32 v86, v56, v57
    v_cvt_pk_bf16_f32 v87, v58, v59
    v_exp_f32 v60, v60
    v_exp_f32 v61, v61
    v_exp_f32 v62, v62
    v_exp_f32 v63, v63
    v_exp_f32 v64, v64
    v_exp_f32 v65, v65
    v_exp_f32 v66, v66
    v_exp_f32 v67, v67
    s_waitcnt lgkmcnt(0)
    v_mfma_f32_32x32x16_bf16 v[92:107], v[36:39], v[84:87], v[92:107]
    v_cvt_pk_bf16_f32 v88, v60, v61
    v_cvt_pk_bf16_f32 v89, v62, v63
    v_cvt_pk_bf16_f32 v90, v64, v65
    v_cvt_pk_bf16_f32 v91, v66, v67
    s_nop 1
    v_mfma_f32_32x32x16_bf16 v[92:107], v[40:43], v[88:91], v[92:107]
    ds_read_b128 v[28:31], v10 offset:10752
    s_mov_b64 exec, s[50:51]
    ds_read_b128 v[32:35], v10 offset:11776
    s_mov_b64 exec, s[52:53]
    ds_read_b128 v[44:47], v124 offset:7680
    ds_read_b128 v[48:51], v124 offset:8448
    s_mov_b64 exec, -1
    s_waitcnt lgkmcnt(4)
    v_mfma_f32_32x32x16_bf16 v[52:67], v[20:23], v[12:15], 0
    v_exp_f32 v68, v68
    v_exp_f32 v69, v69
    v_exp_f32 v70, v70
    v_exp_f32 v71, v71
    v_exp_f32 v72, v72
    v_exp_f32 v73, v73
    v_exp_f32 v74, v74
    v_exp_f32 v75, v75
    v_mfma_f32_32x32x16_bf16 v[52:67], v[24:27], v[16:19], v[52:67]
    v_cvt_pk_bf16_f32 v84, v68, v69
    v_cvt_pk_bf16_f32 v85, v70, v71
    v_cvt_pk_bf16_f32 v86, v72, v73
    v_cvt_pk_bf16_f32 v87, v74, v75
    v_exp_f32 v76, v76
    v_exp_f32 v77, v77
    v_exp_f32 v78, v78
    v_exp_f32 v79, v79
    v_exp_f32 v80, v80
    v_exp_f32 v81, v81
    v_exp_f32 v82, v82
    v_exp_f32 v83, v83
    s_waitcnt lgkmcnt(0)
    v_mfma_f32_32x32x16_bf16 v[92:107], v[44:47], v[84:87], v[92:107]
    v_cvt_pk_bf16_f32 v88, v76, v77
    v_cvt_pk_bf16_f32 v89, v78, v79
    v_cvt_pk_bf16_f32 v90, v80, v81
    v_cvt_pk_bf16_f32 v91, v82, v83
    s_nop 1
    v_mfma_f32_32x32x16_bf16 v[92:107], v[48:51], v[88:91], v[92:107]
    s_waitcnt vmcnt(0)
    s_barrier
    s_add_u32 m0, s49, s56
    s_add_u32 s56, s56, 24576
    buffer_load_dwordx4 v1, s[44:47], s48 offen offset:0 lds
    buffer_load_dwordx4 v1, s[44:47], s48 offen offset:1024 lds
    buffer_load_dwordx4 v1, s[44:47], s48 offen offset:2048 lds
    s_cmp_ge_u32 s56, 73728
    s_cselect_b32 s56, 0, s56
    s_add_u32 s48, s48, 12288
    ds_read_b128 v[20:23], v11 offset:0
    s_mov_b64 exec, s[50:51]
    ds_read_b128 v[24:27], v11 offset:1024
    s_mov_b64 exec, s[52:53]
    ds_read_b128 v[36:39], v124 offset:9216
    ds_read_b128 v[40:43], v124 offset:9984
    s_mov_b64 exec, -1
    s_waitcnt lgkmcnt(4)
    v_mfma_f32_32x32x16_bf16 v[68:83], v[28:31], v[12:15], 0
    v_exp_f32 v52, v52
    v_exp_f32 v53, v53
    v_exp_f32 v54, v54
    v_exp_f32 v55, v55
    v_exp_f32 v56, v56
    v_exp_f32 v57, v57
    v_exp_f32 v58, v58
    v_exp_f32 v59, v59
    v_mfma_f32_32x32x16_bf16 v[68:83], v[32:35], v[16:19], v[68:83]
    v_cvt_pk_bf16_f32 v84, v52, v53
    v_cvt_pk_bf16_f32 v85, v54, v55
    v_cvt_pk_bf16_f32 v86, v56, v57
    v_cvt_pk_bf16_f32 v87, v58, v59
    v_exp_f32 v60, v60
    v_exp_f32 v61, v61
    v_exp_f32 v62, v62
    v_exp_f32 v63, v63
    v_exp_f32 v64, v64
    v_exp_f32 v65, v65
    v_exp_f32 v66, v66
    v_exp_f32 v67, v67
    s_waitcnt lgkmcnt(0)
    v_mfma_f32_32x32x16_bf16 v[92:107], v[36:39], v[84:87], v[92:107]
    v_cvt_pk_bf16_f32 v88, v60, v61
    v_cvt_pk_bf16_f32 v89, v62, v63
    v_cvt_pk_bf16_f32 v90, v64, v65
    v_cvt_pk_bf16_f32 v91, v66, v67
    s_nop 1
    v_mfma_f32_32x32x16_bf16 v[92:107], v[40:43], v[88:91], v[92:107]
    ds_read_b128 v[28:31], v11 offset:1536
    s_mov_b64 exec, s[50:51]
    ds_read_b128 v[32:35], v11 offset:2560
    s_mov_b64 exec, s[52:53]
    ds_read_b128 v[44:47], v124 offset:10752
    ds_read_b128 v[48:51], v124 offset:11520
    s_mov_b64 exec, -1
    s_waitcnt lgkmcnt(4)
    v_mfma_f32_32x32x16_bf16 v[52:67], v[20:23], v[12:15], 0
    v_exp_f32 v68, v68
    v_exp_f32 v69, v69
    v_exp_f32 v70, v70
    v_exp_f32 v71, v71
    v_exp_f32 v72, v72
    v_exp_f32 v73, v73
    v_exp_f32 v74, v74
    v_exp_f32 v75, v75
    v_mfma_f32_32x32x16_bf16 v[52:67], v[24:27], v[16:19], v[52:67]
    v_cvt_pk_bf16_f32 v84, v68, v69
    v_cvt_pk_bf16_f32 v85, v70, v71
    v_cvt_pk_bf16_f32 v86, v72, v73
    v_cvt_pk_bf16_f32 v87, v74, v75
    v_exp_f32 v76, v76
    v_exp_f32 v77, v77
    v_exp_f32 v78, v78
    v_exp_f32 v79, v79
    v_exp_f32 v80, v80
    v_exp_f32 v81, v81
    v_exp_f32 v82, v82
    v_exp_f32 v83, v83
    s_waitcnt lgkmcnt(0)
    v_mfma_f32_32x32x16_bf16 v[92:107], v[44:47], v[84:87], v[92:107]
    v_cvt_pk_bf16_f32 v88, v76, v77
    v_cvt_pk_bf16_f32 v89, v78, v79
    v_cvt_pk_bf16_f32 v90, v80, v81
    v_cvt_pk_bf16_f32 v91, v82, v83
    v_mov_b32 v10, v11
    v_add_u32 v124, s57, v2
    v_add_u32 v124, 12288, v124
    s_add_u32 s57, s57, 24576
    s_cmp_ge_u32 s57, 73728
    s_cselect_b32 s57, 0, s57
    v_add_u32 v11, s57, v1
    v_mfma_f32_32x32x16_bf16 v[92:107], v[48:51], v[88:91], v[92:107]
    s_add_u32 s24, s24, 1
    s_cmp_lt_u32 s24, 8
    s_cbranch_scc1 att_loop
    s_nop 15
    v_or_b32 v3, 32, v0
    v_lshlrev_b32 v3, 2, v3
    ds_bpermute_b32 v109, v3, v100
    v_max3_f32 v4, abs(v92), abs(v93), abs(v94)
    v_max3_f32 v4, v4, abs(v95), abs(v96)
    v_max3_f32 v4, v4, abs(v97), abs(v98)
    v_max3_f32 v4, v4, abs(v99), abs(v100)
    v_max3_f32 v4, v4, abs(v101), abs(v102)
    v_max_f32 v4, v4, abs(v103)
    s_mov_b32 s26, 0x7b800000
    s_mov_b32 s27, 0x71800000
    s_waitcnt lgkmcnt(0)
    v_cmp_ngt_f32 vcc, s26, v4
    v_cmp_ngt_f32 s[58:59], s27, v109
    s_or_b64 vcc, vcc, s[58:59]
    s_cbranch_vccnz att_fallback
att_store:
    v_rcp_f32 v109, v109
    v_and_b32 v3, 31, v0
    v_mul_u32_u24 v3, 1280, v3
    v_lshrrev_b32 v4, 5, v0
    v_lshl_add_u32 v3, v4, 3, v3
    s_mul_i32 s26, s23, 40960
    s_mul_i32 s27, s22, 40
    s_add_u32 s26, s26, s27
    v_mul_f32 v92, v92, v109
    v_mul_f32 v93, v93, v109
    v_mul_f32 v94, v94, v109
    v_mul_f32 v95, v95, v109
    v_mul_f32 v96, v96, v109
    v_mul_f32 v97, v97, v109
    v_mul_f32 v98, v98, v109
    v_mul_f32 v99, v99, v109
    v_mul_f32 v100, v100, v109
    v_mul_f32 v101, v101, v109
    v_mul_f32 v102, v102, v109
    v_mul_f32 v103, v103, v109
    v_cvt_pk_bf16_f32 v84, v92, v93
    v_cvt_pk_bf16_f32 v85, v94, v95
    v_cvt_pk_bf16_f32 v86, v96, v97
    v_cvt_pk_bf16_f32 v87, v98, v99
    v_cvt_pk_bf16_f32 v88, v100, v101
    v_cvt_pk_bf16_f32 v89, v102, v103
    buffer_store_dwordx2 v[84:85], v3, s[40:43], s26 offen
    buffer_store_dwordx2 v[86:87], v3, s[40:43], s26 offen offset:16
    s_mov_b64 exec, s[50:51]
    buffer_store_dwordx2 v[88:89], v3, s[40:43], s26 offen offset:32
    s_mov_b64 exec, -1
    s_and_b32 s8, s2, 4
    s_cmp_eq_u32 s8, 0
    s_cselect_b32 s8, s4, s6
    s_cselect_b32 s9, s5, s7
    s_and_b32 s9, s9, 0xffff
    s_mov_b32 s10, 819200
    s_mov_b32 s11, 0x00020000
    s_lshr_b32 s12, s2, 3
    s_mul_i32 s12, s12, 25600
    s_lshl_b32 s13, s25, 10
    s_add_u32 s12, s12, s13
    buffer_load_dwordx4 v[168:171], v1, s[8:11], s12 offen
    s_add_u32 s12, s12, 8192
    buffer_load_dwordx4 v[168:171], v1, s[8:11], s12 offen
    s_add_u32 s12, s12, 8192
    buffer_load_dwordx4 v[168:171], v1, s[8:11], s12 offen
    s_add_u32 s12, s12, 8192
    buffer_load_dwordx4 v[168:171], v1, s[8:11], s12 offen
    s_add_u32 s12, s12, 8192
    s_nop 1
    v_and_b32 v3, 31, v0
    v_lshrrev_b32 v4, 5, v0
    v_lshlrev_b32 v4, 2, v4
    v_sub_u32 v3, v3, v4
    v_add_u32 v3, 18, v3
    v_mov_b32 v112, 0x5555
    v_mov_b32 v113, 0
    v_lshlrev_b64 v[112:113], v3, v[112:113]
    v_and_b32 v112, s19, v112
    v_mov_b32 v114, 0xff800000
    v_mfma_f32_32x32x16_bf16 v[52:67], v[136:139], v[128:131], 0
    v_mfma_f32_32x32x16_bf16 v[52:67], v[140:143], v[132:135], v[52:67]
    v_mfma_f32_32x32x16_bf16 v[68:83], v[144:147], v[128:131], 0
    v_mfma_f32_32x32x16_bf16 v[68:83], v[148:151], v[132:135], v[68:83]
    s_nop 15
    v_bfe_i32 v3, v112, 16, 1
    v_bfi_b32 v60, v3, v60, v114
    v_bfe_i32 v4, v112, 17, 1
    v_bfi_b32 v61, v4, v61, v114
    v_bfe_i32 v5, v112, 18, 1
    v_bfi_b32 v62, v5, v62, v114
    v_bfe_i32 v6, v112, 19, 1
    v_bfi_b32 v63, v6, v63, v114
    v_bfe_i32 v3, v112, 24, 1
    v_bfi_b32 v64, v3, v64, v114
    v_bfe_i32 v4, v112, 25, 1
    v_bfi_b32 v65, v4, v65, v114
    v_bfe_i32 v5, v112, 26, 1
    v_bfi_b32 v66, v5, v66, v114
    v_bfe_i32 v6, v112, 27, 1
    v_bfi_b32 v67, v6, v67, v114
    v_bfe_i32 v3, v113, 0, 1
    v_bfi_b32 v68, v3, v68, v114
    v_bfe_i32 v4, v113, 1, 1
    v_bfi_b32 v69, v4, v69, v114
    v_bfe_i32 v5, v113, 2, 1
    v_bfi_b32 v70, v5, v70, v114
    v_bfe_i32 v6, v113, 3, 1
    v_bfi_b32 v71, v6, v71, v114
    v_bfe_i32 v3, v113, 8, 1
    v_bfi_b32 v72, v3, v72, v114
    v_bfe_i32 v4, v113, 9, 1
    v_bfi_b32 v73, v4, v73, v114
    v_bfe_i32 v5, v113, 10, 1
    v_bfi_b32 v74, v5, v74, v114
    v_bfe_i32 v6, v113, 11, 1
    v_bfi_b32 v75, v6, v75, v114
    v_bfe_i32 v3, v113, 16, 1
    v_bfi_b32 v76, v3, v76, v114
    v_bfe_i32 v4, v113, 17, 1
    v_bfi_b32 v77, v4, v77, v114
    v_bfe_i32 v5, v113, 18, 1
    v_bfi_b32 v78, v5, v78, v114
    v_bfe_i32 v6, v113, 19, 1
    v_bfi_b32 v79, v6, v79, v114
    v_bfe_i32 v3, v113, 24, 1
    v_bfi_b32 v80, v3, v80, v114
    v_bfe_i32 v4, v113, 25, 1
    v_bfi_b32 v81, v4, v81, v114
    v_bfe_i32 v5, v113, 26, 1
    v_bfi_b32 v82, v5, v82, v114
    v_bfe_i32 v6, v113, 27, 1
    v_bfi_b32 v83, v6, v83, v114
    v_max3_f32 v108, v60, v61, v62
    v_max3_f32 v108, v108, v63, v64
    v_max3_f32 v108, v108, v65, v66
    v_max3_f32 v108, v108, v67, v68
    v_max3_f32 v108, v108, v69, v70
    v_max3_f32 v108, v108, v71, v72
    v_max3_f32 v108, v108, v73, v74
    v_max3_f32 v108, v108, v75, v76
    v_max3_f32 v108, v108, v77, v78
    v_max3_f32 v108, v108, v79, v80
    v_max3_f32 v108, v108, v81, v82
    v_max_f32 v108, v108, v83
    v_mov_b32 v3, v108
    s_nop 1
    v_permlane32_swap_b32 v108, v3
    v_max_f32 v108, v108, v3
    v_sub_f32 v60, v60, v108
    v_sub_f32 v61, v61, v108
    v_sub_f32 v62, v62, v108
    v_sub_f32 v63, v63, v108
    v_sub_f32 v64, v64, v108
    v_sub_f32 v65, v65, v108
    v_sub_f32 v66, v66, v108
    v_sub_f32 v67, v67, v108
    v_sub_f32 v68, v68, v108
    v_sub_f32 v69, v69, v108
    v_sub_f32 v70, v70, v108
    v_sub_f32 v71, v71, v108
    v_sub_f32 v72, v72, v108
    v_sub_f32 v73, v73, v108
    v_sub_f32 v74, v74, v108
    v_sub_f32 v75, v75, v108
    v_sub_f32 v76, v76, v108
    v_sub_f32 v77, v77, v108
    v_sub_f32 v78, v78, v108
    v_sub_f32 v79, v79, v108
    v_sub_f32 v80, v80, v108
    v_sub_f32 v81, v81, v108
    v_sub_f32 v82, v82, v108
    v_sub_f32 v83, v83, v108
    v_exp_f32 v60, v60
    v_exp_f32 v61, v61
    v_exp_f32 v62, v62
    v_exp_f32 v63, v63
    v_exp_f32 v64, v64
    v_exp_f32 v65, v65
    v_exp_f32 v66, v66
    v_exp_f32 v67, v67
    v_exp_f32 v68, v68
    v_exp_f32 v69, v69
    v_exp_f32 v70, v70
    v_exp_f32 v71, v71
    v_exp_f32 v72, v72
    v_exp_f32 v73, v73
    v_exp_f32 v74, v74
    v_exp_f32 v75, v75
    v_exp_f32 v76, v76
    v_exp_f32 v77, v77
    v_exp_f32 v78, v78
    v_exp_f32 v79, v79
    v_exp_f32 v80, v80
    v_exp_f32 v81, v81
    v_exp_f32 v82, v82
    v_exp_f32 v83, v83
    s_nop 0
    v_cvt_pk_bf16_f32 v88, v60, v61
    v_cvt_pk_bf16_f32 v89, v62, v63
    v_cvt_pk_bf16_f32 v90, v64, v65
    v_cvt_pk_bf16_f32 v91, v66, v67
    s_nop 1
    v_mfma_f32_32x32x16_bf16 v[92:107], v[156:159], v[88:91], 0
    v_cvt_pk_bf16_f32 v52, v68, v69
    v_cvt_pk_bf16_f32 v53, v70, v71
    v_cvt_pk_bf16_f32 v54, v72, v73
    v_cvt_pk_bf16_f32 v55, v74, v75
    v_cvt_pk_bf16_f32 v56, v76, v77
    v_cvt_pk_bf16_f32 v57, v78, v79
    v_cvt_pk_bf16_f32 v58, v80, v81
    v_cvt_pk_bf16_f32 v59, v82, v83
    s_nop 1
    v_mfma_f32_32x32x16_bf16 v[92:107], v[160:163], v[52:55], v[92:107]
    v_mfma_f32_32x32x16_bf16 v[92:107], v[164:167], v[56:59], v[92:107]
    s_nop 15
    v_or_b32 v3, 32, v0
    v_lshlrev_b32 v3, 2, v3
    ds_bpermute_b32 v109, v3, v100
    s_waitcnt lgkmcnt(0)
    v_rcp_f32 v109, v109
    v_and_b32 v3, 31, v0
    v_mul_u32_u24 v3, 1280, v3
    v_lshrrev_b32 v4, 5, v0
    v_lshl_add_u32 v3, v4, 3, v3
    s_mul_i32 s26, s18, 40960
    s_mul_i32 s27, s17, 40
    s_add_u32 s26, s26, s27
    v_mul_f32 v92, v92, v109
    v_mul_f32 v93, v93, v109
    v_mul_f32 v94, v94, v109
    v_mul_f32 v95, v95, v109
    v_mul_f32 v96, v96, v109
    v_mul_f32 v97, v97, v109
    v_mul_f32 v98, v98, v109
    v_mul_f32 v99, v99, v109
    v_mul_f32 v100, v100, v109
    v_mul_f32 v101, v101, v109
    v_mul_f32 v102, v102, v109
    v_mul_f32 v103, v103, v109
    v_cvt_pk_bf16_f32 v84, v92, v93
    v_cvt_pk_bf16_f32 v85, v94, v95
    v_cvt_pk_bf16_f32 v86, v96, v97
    v_cvt_pk_bf16_f32 v87, v98, v99
    v_cvt_pk_bf16_f32 v88, v100, v101
    v_cvt_pk_bf16_f32 v89, v102, v103
    buffer_store_dwordx2 v[84:85], v3, s[76:79], s26 offen
    buffer_store_dwordx2 v[86:87], v3, s[76:79], s26 offen offset:16
    s_mov_b64 exec, s[50:51]
    buffer_store_dwordx2 v[88:89], v3, s[76:79], s26 offen offset:32
    s_mov_b64 exec, -1
    s_endpgm
att_fallback:
    v_mov_b32 v18, 0
    v_mov_b32 v108, 0xff800000
    v_mov_b32 v92, 0
    v_mov_b32 v93, 0
    v_mov_b32 v94, 0
    v_mov_b32 v95, 0
    v_mov_b32 v96, 0
    v_mov_b32 v97, 0
    v_mov_b32 v98, 0
    v_mov_b32 v99, 0
    v_mov_b32 v100, 0
    v_mov_b32 v101, 0
    v_mov_b32 v102, 0
    v_mov_b32 v103, 0
    v_mov_b32 v104, 0
    v_mov_b32 v105, 0
    v_mov_b32 v106, 0
    v_mov_b32 v107, 0
    s_mul_i32 s48, s22, 98304
    s_mov_b32 s24, 0
att_fbloop:
    buffer_load_dwordx4 v[20:23], v1, s[32:35], s48 offen
    s_mov_b64 exec, s[50:51]
    buffer_load_dwordx4 v[24:27], v1, s[32:35], s48 offen offset:1024
    s_mov_b64 exec, s[52:53]
    buffer_load_dwordx4 v[36:39], v2, s[36:39], s48 offen
    buffer_load_dwordx4 v[40:43], v2, s[36:39], s48 offen offset:768
    s_mov_b64 exec, -1
    s_waitcnt vmcnt(0)
    v_mfma_f32_32x32x16_bf16 v[52:67], v[20:23], v[12:15], 0
    v_mfma_f32_32x32x16_bf16 v[52:67], v[24:27], v[16:19], v[52:67]
    s_nop 15
    v_max3_f32 v110, v52, v53, v54
    v_max3_f32 v110, v110, v55, v56
    v_max3_f32 v110, v110, v57, v58
    v_max3_f32 v110, v110, v59, v60
    v_max3_f32 v110, v110, v61, v62
    v_max3_f32 v110, v110, v63, v64
    v_max3_f32 v110, v110, v65, v66
    v_max_f32 v110, v110, v67
    v_mov_b32 v3, v110
    s_nop 1
    v_permlane32_swap_b32 v110, v3
    v_max_f32 v110, v110, v3
    v_max_f32 v110, v110, v108
    v_sub_f32 v111, v108, v110
    v_exp_f32 v111, v111
    v_mov_b32 v108, v110
    v_mul_f32 v92, v92, v111
    v_mul_f32 v93, v93, v111
    v_mul_f32 v94, v94, v111
    v_mul_f32 v95, v95, v111
    v_mul_f32 v96, v96, v111
    v_mul_f32 v97, v97, v111
    v_mul_f32 v98, v98, v111
    v_mul_f32 v99, v99, v111
    v_mul_f32 v100, v100, v111
    v_mul_f32 v101, v101, v111
    v_mul_f32 v102, v102, v111
    v_mul_f32 v103, v103, v111
    v_mul_f32 v104, v104, v111
    v_mul_f32 v105, v105, v111
    v_mul_f32 v106, v106, v111
    v_mul_f32 v107, v107, v111
    v_sub_f32 v52, v52, v108
    v_exp_f32 v52, v52
    v_sub_f32 v53, v53, v108
    v_exp_f32 v53, v53
    v_sub_f32 v54, v54, v108
    v_exp_f32 v54, v54
    v_sub_f32 v55, v55, v108
    v_exp_f32 v55, v55
    v_sub_f32 v56, v56, v108
    v_exp_f32 v56, v56
    v_sub_f32 v57, v57, v108
    v_exp_f32 v57, v57
    v_sub_f32 v58, v58, v108
    v_exp_f32 v58, v58
    v_sub_f32 v59, v59, v108
    v_exp_f32 v59, v59
    v_sub_f32 v60, v60, v108
    v_exp_f32 v60, v60
    v_sub_f32 v61, v61, v108
    v_exp_f32 v61, v61
    v_sub_f32 v62, v62, v108
    v_exp_f32 v62, v62
    v_sub_f32 v63, v63, v108
    v_exp_f32 v63, v63
    v_sub_f32 v64, v64, v108
    v_exp_f32 v64, v64
    v_sub_f32 v65, v65, v108
    v_exp_f32 v65, v65
    v_sub_f32 v66, v66, v108
    v_exp_f32 v66, v66
    v_sub_f32 v67, v67, v108
    v_exp_f32 v67, v67
    s_nop 0
    v_cvt_pk_bf16_f32 v84, v52, v53
    v_cvt_pk_bf16_f32 v85, v54, v55
    v_cvt_pk_bf16_f32 v86, v56, v57
    v_cvt_pk_bf16_f32 v87, v58, v59
    v_cvt_pk_bf16_f32 v88, v60, v61
    v_cvt_pk_bf16_f32 v89, v62, v63
    v_cvt_pk_bf16_f32 v90, v64, v65
    v_cvt_pk_bf16_f32 v91, v66, v67
    s_nop 1
    v_mfma_f32_32x32x16_bf16 v[92:107], v[36:39], v[84:87], v[92:107]
    v_mfma_f32_32x32x16_bf16 v[92:107], v[40:43], v[88:91], v[92:107]
    s_add_u32 s48, s48, 1536
    s_add_u32 s24, s24, 1
    s_cmp_lt_u32 s24, 64
    s_nop 15
    s_cbranch_scc1 att_fbloop
    v_or_b32 v3, 32, v0
    v_lshlrev_b32 v3, 2, v3
    ds_bpermute_b32 v109, v3, v100
    s_waitcnt lgkmcnt(0)
    s_branch att_store
att_end:
    s_endpgm
.p2align 8
.globl out_kernel
.type out_kernel,@function
out_kernel:
    s_cmp_ge_u32 s2, 256
    s_cbranch_scc1 out_end
    s_load_dwordx16 s[4:19], s[0:1], 0
    s_load_dwordx2 s[20:21], s[0:1], 64
    s_and_b32 s26, s2, 7
    s_lshr_b32 s27, s2, 3
    s_lshr_b32 s22, s26, 2
    s_and_b32 s26, s26, 3
    s_lshl_b32 s26, s26, 3
    s_and_b32 s23, s27, 7
    s_add_u32 s23, s23, s26
    s_lshr_b32 s24, s27, 3
    v_lshrrev_b32 v1, 6, v0
    v_and_b32 v0, 63, v0
    v_readfirstlane_b32 s25, v1
    s_waitcnt lgkmcnt(0)
    s_mov_b32 s54, 0
    s_mov_b32 s55, s25
    s_lshl_b32 s52, s22, 24
    s_cmp_eq_u32 s22, 0
    s_cselect_b32 s32, s8, s14
    s_cselect_b32 s33, s9, s15
    s_add_u32 s52, s52, 9437184
    s_add_u32 s28, s20, s52
    s_addc_u32 s29, s21, 0
    s_mov_b32 s36, s16
    s_mov_b32 s37, s17
    s_mov_b32 s30, 2621440
    s_mov_b32 s34, 819200
    s_mov_b32 s38, 5242880
    s_and_b32 s29, s29, 0xffff
    s_mov_b32 s31, 0x00020000
    s_and_b32 s33, s33, 0xffff
    s_mov_b32 s35, 0x00020000
    s_and_b32 s37, s37, 0xffff
    s_mov_b32 s39, 0x00020000
    v_lshrrev_b32 v4, 3, v0
    v_mul_u32_u24 v1, 1280, v4
    v_and_b32 v4, 7, v0
    v_lshrrev_b32 v5, 4, v0
    v_xor_b32 v4, v4, v5
    v_lshl_add_u32 v1, v4, 4, v1
    v_xor_b32 v2, 64, v1
    v_lshrrev_b32 v4, 2, v0
    v_mul_u32_u24 v3, 1280, v4
    v_and_b32 v4, 3, v0
    v_lshl_add_u32 v3, v4, 4, v3
    s_mul_i32 s52, s25, 2
    s_add_u32 s52, s52, 0
    s_and_b32 s52, s52, 7
    s_lshl_b32 s46, s52, 10
    s_mul_i32 s53, s23, 8
    s_add_u32 s52, s52, s53
    s_mul_i32 s40, s52, 10240
    s_mul_i32 s52, s25, 2
    s_add_u32 s52, s52, 1
    s_and_b32 s52, s52, 7
    s_lshl_b32 s47, s52, 10
    s_mul_i32 s53, s23, 8
    s_add_u32 s52, s52, s53
    s_mul_i32 s41, s52, 10240
    s_mul_i32 s52, s25, 4
    s_add_u32 s52, s52, 0
    s_lshl_b32 s48, s52, 10
    s_add_u32 s48, s48, 8192
    s_and_b32 s53, s52, 3
    s_mul_i32 s53, s53, 20480
    s_lshr_b32 s52, s52, 2
    s_lshl_b32 s52, s52, 6
    s_add_u32 s53, s53, s52
    s_mul_i32 s52, s24, 320
    s_add_u32 s42, s53, s52
    s_mul_i32 s52, s25, 4
    s_add_u32 s52, s52, 1
    s_lshl_b32 s49, s52, 10
    s_add_u32 s49, s49, 8192
    s_and_b32 s53, s52, 3
    s_mul_i32 s53, s53, 20480
    s_lshr_b32 s52, s52, 2
    s_lshl_b32 s52, s52, 6
    s_add_u32 s53, s53, s52
    s_mul_i32 s52, s24, 320
    s_add_u32 s43, s53, s52
    s_mul_i32 s52, s25, 4
    s_add_u32 s52, s52, 2
    s_lshl_b32 s50, s52, 10
    s_add_u32 s50, s50, 8192
    s_and_b32 s53, s52, 3
    s_mul_i32 s53, s53, 20480
    s_lshr_b32 s52, s52, 2
    s_lshl_b32 s52, s52, 6
    s_add_u32 s53, s53, s52
    s_mul_i32 s52, s24, 320
    s_add_u32 s44, s53, s52
    s_mul_i32 s52, s25, 4
    s_add_u32 s52, s52, 3
    s_lshl_b32 s51, s52, 10
    s_add_u32 s51, s51, 8192
    s_and_b32 s53, s52, 3
    s_mul_i32 s53, s53, 20480
    s_lshr_b32 s52, s52, 2
    s_lshl_b32 s52, s52, 6
    s_add_u32 s53, s53, s52
    s_mul_i32 s52, s24, 320
    s_add_u32 s45, s53, s52
    s_add_u32 s62, s24, s23
    s_cmp_ge_u32 s62, 10
    s_cselect_b32 s52, 10, 0
    s_sub_u32 s62, s62, s52
    s_cmp_ge_u32 s62, 10
    s_cselect_b32 s52, 10, 0
    s_sub_u32 s62, s62, s52
    s_cmp_ge_u32 s62, 10
    s_cselect_b32 s52, 10, 0
    s_sub_u32 s62, s62, s52
    s_cmp_ge_u32 s62, 10
    s_cselect_b32 s52, 10, 0
    s_sub_u32 s62, s62, s52
    s_lshl_b32 s52, s62, 7
    s_mul_i32 s53, s62, 81920
    s_add_u32 s40, s40, s52
    s_add_u32 s41, s41, s52
    s_add_u32 s42, s42, s53
    s_add_u32 s43, s43, s53
    s_add_u32 s44, s44, s53
    s_add_u32 s45, s45, s53
    s_add_u32 s62, s62, 1
    s_cmp_eq_u32 s62, 10
    s_cselect_b32 s63, 4294966016, 0
    s_cselect_b32 s64, 4294148096, 0
    s_cselect_b32 s62, 0, s62
    s_add_u32 s63, s63, 128
    s_add_u32 s64, s64, 81920
    s_add_u32 m0, s46, 0
    s_nop 0
    buffer_load_dwordx4 v1, s[28:31], s40 offen lds
    s_add_u32 s40, s40, s63
    s_add_u32 m0, s47, 0
    s_nop 0
    buffer_load_dwordx4 v2, s[28:31], s41 offen lds
    s_add_u32 s41, s41, s63
    s_add_u32 m0, s48, 0
    s_nop 0
    buffer_load_dwordx4 v3, s[32:35], s42 offen lds
    s_add_u32 s42, s42, s64
    s_add_u32 m0, s49, 0
    s_nop 0
    buffer_load_dwordx4 v3, s[32:35], s43 offen lds
    s_add_u32 s43, s43, s64
    s_add_u32 m0, s50, 0
    s_nop 0
    buffer_load_dwordx4 v3, s[32:35], s44 offen lds
    s_add_u32 s44, s44, s64
    s_add_u32 m0, s51, 0
    s_nop 0
    buffer_load_dwordx4 v3, s[32:35], s45 offen lds
    s_add_u32 s45, s45, s64
    v_and_b32 v4, 31, v0
    s_mul_i32 s52, s54, 64
    v_add_u32 v4, s52, v4
    v_lshlrev_b32 v4, 7, v4
    v_bfe_u32 v5, v0, 1, 3
    v_lshrrev_b32 v6, 5, v0
    v_add_u32 v7, 0, v6
    v_xor_b32 v7, v7, v5
    v_lshl_add_u32 v10, v7, 4, v4
    v_add_u32 v14, 28672, v10
    v_add_u32 v18, 57344, v10
    v_add_u32 v22, 86016, v10
    v_add_u32 v26, 114688, v10
    v_add_u32 v7, 2, v6
    v_xor_b32 v7, v7, v5
    v_lshl_add_u32 v11, v7, 4, v4
    v_add_u32 v15, 28672, v11
    v_add_u32 v19, 57344, v11
    v_add_u32 v23, 86016, v11
    v_add_u32 v27, 114688, v11
    v_add_u32 v7, 4, v6
    v_xor_b32 v7, v7, v5
    v_lshl_add_u32 v12, v7, 4, v4
    v_add_u32 v16, 28672, v12
    v_add_u32 v20, 57344, v12
    v_add_u32 v24, 86016, v12
    v_add_u32 v28, 114688, v12
    v_add_u32 v7, 6, v6
    v_xor_b32 v7, v7, v5
    v_lshl_add_u32 v13, v7, 4, v4
    v_add_u32 v17, 28672, v13
    v_add_u32 v21, 57344, v13
    v_add_u32 v25, 86016, v13
    v_add_u32 v29, 114688, v13
    v_bfe_u32 v4, v0, 2, 2
    v_lshl_add_u32 v5, v6, 3, v4
    v_lshlrev_b32 v5, 6, v5
    v_bfe_u32 v7, v0, 4, 1
    v_lshl_add_u32 v5, v7, 5, v5
    v_and_b32 v7, 3, v0
    v_lshl_add_u32 v5, v7, 3, v5
    s_mul_i32 s52, s55, 4096
    s_add_u32 s52, s52, 8192
    s_add_u32 s53, s52, 0
    v_add_u32 v30, s53, v5
    s_add_u32 s53, s52, 28672
    v_add_u32 v31, s53, v5
    s_add_u32 s53, s52, 57344
    v_add_u32 v32, s53, v5
    s_add_u32 s53, s52, 86016
    v_add_u32 v33, s53, v5
    s_add_u32 s53, s52, 114688
    v_add_u32 v34, s53, v5
    v_mov_b32 v60, 0
    v_mov_b32 v61, 0
    v_mov_b32 v62, 0
    v_mov_b32 v63, 0
    v_mov_b32 v64, 0
    v_mov_b32 v65, 0
    v_mov_b32 v66, 0
    v_mov_b32 v67, 0
    v_mov_b32 v68, 0
    v_mov_b32 v69, 0
    v_mov_b32 v70, 0
    v_mov_b32 v71, 0
    v_mov_b32 v72, 0
    v_mov_b32 v73, 0
    v_mov_b32 v74, 0
    v_mov_b32 v75, 0
    v_mov_b32 v76, 0
    v_mov_b32 v77, 0
    v_mov_b32 v78, 0
    v_mov_b32 v79, 0
    v_mov_b32 v80, 0
    v_mov_b32 v81, 0
    v_mov_b32 v82, 0
    v_mov_b32 v83, 0
    v_mov_b32 v84, 0
    v_mov_b32 v85, 0
    v_mov_b32 v86, 0
    v_mov_b32 v87, 0
    v_mov_b32 v88, 0
    v_mov_b32 v89, 0
    v_mov_b32 v90, 0
    v_mov_b32 v91, 0
    s_add_u32 s62, s62, 1
    s_cmp_eq_u32 s62, 10
    s_cselect_b32 s63, 4294966016, 0
    s_cselect_b32 s64, 4294148096, 0
    s_cselect_b32 s62, 0, s62
    s_add_u32 s63, s63, 128
    s_add_u32 s64, s64, 81920
    s_add_u32 m0, s46, 28672
    s_nop 0
    buffer_load_dwordx4 v1, s[28:31], s40 offen lds
    s_add_u32 s40, s40, s63
    s_add_u32 m0, s47, 28672
    s_nop 0
    buffer_load_dwordx4 v2, s[28:31], s41 offen lds
    s_add_u32 s41, s41, s63
    s_add_u32 m0, s48, 28672
    s_nop 0
    buffer_load_dwordx4 v3, s[32:35], s42 offen lds
    s_add_u32 s42, s42, s64
    s_add_u32 m0, s49, 28672
    s_nop 0
    buffer_load_dwordx4 v3, s[32:35], s43 offen lds
    s_add_u32 s43, s43, s64
    s_add_u32 m0, s50, 28672
    s_nop 0
    buffer_load_dwordx4 v3, s[32:35], s44 offen lds
    s_add_u32 s44, s44, s64
    s_add_u32 m0, s51, 28672
    s_nop 0
    buffer_load_dwordx4 v3, s[32:35], s45 offen lds
    s_add_u32 s45, s45, s64
    s_add_u32 s62, s62, 1
    s_cmp_eq_u32 s62, 10
    s_cselect_b32 s63, 4294966016, 0
    s_cselect_b32 s64, 4294148096, 0
    s_cselect_b32 s62, 0, s62
    s_add_u32 s63, s63, 128
    s_add_u32 s64, s64, 81920
    s_add_u32 m0, s46, 57344
    s_nop 0
    buffer_load_dwordx4 v1, s[28:31], s40 offen lds
    s_add_u32 s40, s40, s63
    s_add_u32 m0, s47, 57344
    s_nop 0
    buffer_load_dwordx4 v2, s[28:31], s41 offen lds
    s_add_u32 s41, s41, s63
    s_add_u32 m0, s48, 57344
    s_nop 0
    buffer_load_dwordx4 v3, s[32:35], s42 offen lds
    s_add_u32 s42, s42, s64
    s_add_u32 m0, s49, 57344
    s_nop 0
    buffer_load_dwordx4 v3, s[32:35], s43 offen lds
    s_add_u32 s43, s43, s64
    s_add_u32 m0, s50, 57344
    s_nop 0
    buffer_load_dwordx4 v3, s[32:35], s44 offen lds
    s_add_u32 s44, s44, s64
    s_add_u32 m0, s51, 57344
    s_nop 0
    buffer_load_dwordx4 v3, s[32:35], s45 offen lds
    s_add_u32 s45, s45, s64
    s_add_u32 s62, s62, 1
    s_cmp_eq_u32 s62, 10
    s_cselect_b32 s63, 4294966016, 0
    s_cselect_b32 s64, 4294148096, 0
    s_cselect_b32 s62, 0, s62
    s_add_u32 s63, s63, 128
    s_add_u32 s64, s64, 81920
    s_add_u32 m0, s46, 86016
    s_nop 0
    buffer_load_dwordx4 v1, s[28:31], s40 offen lds
    s_add_u32 s40, s40, s63
    s_add_u32 m0, s47, 86016
    s_nop 0
    buffer_load_dwordx4 v2, s[28:31], s41 offen lds
    s_add_u32 s41, s41, s63
    s_add_u32 m0, s48, 86016
    s_nop 0
    buffer_load_dwordx4 v3, s[32:35], s42 offen lds
    s_add_u32 s42, s42, s64
    s_add_u32 m0, s49, 86016
    s_nop 0
    buffer_load_dwordx4 v3, s[32:35], s43 offen lds
    s_add_u32 s43, s43, s64
    s_add_u32 m0, s50, 86016
    s_nop 0
    buffer_load_dwordx4 v3, s[32:35], s44 offen lds
    s_add_u32 s44, s44, s64
    s_add_u32 m0, s51, 86016
    s_nop 0
    buffer_load_dwordx4 v3, s[32:35], s45 offen lds
    s_add_u32 s45, s45, s64
    s_waitcnt vmcnt(18)
    s_barrier
    ds_read_b128 v[36:39], v10 offset:0
    ds_read_b128 v[40:43], v10 offset:4096
    ds_read_b64_tr_b16 v[52:53], v30 offset:0
    ds_read_b64_tr_b16 v[54:55], v30 offset:256
    ds_read_b128 v[44:47], v11 offset:0
    ds_read_b128 v[48:51], v11 offset:4096
    ds_read_b64_tr_b16 v[56:57], v30 offset:1024
    ds_read_b64_tr_b16 v[58:59], v30 offset:1280
    s_waitcnt lgkmcnt(4)
    v_mfma_f32_32x32x16_bf16 v[60:75], v[52:55], v[36:39], v[60:75]
    s_add_u32 s62, s62, 1
    s_cmp_eq_u32 s62, 10
    s_cselect_b32 s63, 4294966016, 0
    s_cselect_b32 s64, 4294148096, 0
    s_cselect_b32 s62, 0, s62
    s_add_u32 s63, s63, 128
    s_add_u32 s64, s64, 81920
    s_add_u32 m0, s46, 114688
    s_nop 0
    buffer_load_dwordx4 v1, s[28:31], s40 offen lds
    s_add_u32 s40, s40, s63
    v_mfma_f32_32x32x16_bf16 v[76:91], v[52:55], v[40:43], v[76:91]
    s_add_u32 m0, s47, 114688
    s_nop 0
    buffer_load_dwordx4 v2, s[28:31], s41 offen lds
    s_add_u32 s41, s41, s63
    ds_read_b128 v[36:39], v12 offset:0
    ds_read_b128 v[40:43], v12 offset:4096
    ds_read_b64_tr_b16 v[52:53], v30 offset:2048
    ds_read_b64_tr_b16 v[54:55], v30 offset:2304
    s_waitcnt lgkmcnt(4)
    v_mfma_f32_32x32x16_bf16 v[60:75], v[56:59], v[44:47], v[60:75]
    s_add_u32 m0, s48, 114688
    s_nop 0
    buffer_load_dwordx4 v3, s[32:35], s42 offen lds
    s_add_u32 s42, s42, s64
    v_mfma_f32_32x32x16_bf16 v[76:91], v[56:59], v[48:51], v[76:91]
    ds_read_b128 v[44:47], v13 offset:0
    ds_read_b128 v[48:51], v13 offset:4096
    ds_read_b64_tr_b16 v[56:57], v30 offset:3072
    ds_read_b64_tr_b16 v[58:59], v30 offset:3328
    s_waitcnt lgkmcnt(4)
    v_mfma_f32_32x32x16_bf16 v[60:75], v[52:55], v[36:39], v[60:75]
    s_add_u32 m0, s49, 114688
    s_nop 0
    buffer_load_dwordx4 v3, s[32:35], s43 offen lds
    s_add_u32 s43, s43, s64
    v_mfma_f32_32x32x16_bf16 v[76:91], v[52:55], v[40:43], v[76:91]
    s_add_u32 m0, s50, 114688
    s_nop 0
    buffer_load_dwordx4 v3, s[32:35], s44 offen lds
    s_add_u32 s44, s44, s64
    s_waitcnt lgkmcnt(0)
    v_mfma_f32_32x32x16_bf16 v[60:75], v[56:59], v[44:47], v[60:75]
    s_add_u32 m0, s51, 114688
    s_nop 0
    buffer_load_dwordx4 v3, s[32:35], s45 offen lds
    s_add_u32 s45, s45, s64
    v_mfma_f32_32x32x16_bf16 v[76:91], v[56:59], v[48:51], v[76:91]
    s_waitcnt vmcnt(18)
    s_barrier
    ds_read_b128 v[36:39], v14 offset:0
    ds_read_b128 v[40:43], v14 offset:4096
    ds_read_b64_tr_b16 v[52:53], v31 offset:0
    ds_read_b64_tr_b16 v[54:55], v31 offset:256
    ds_read_b128 v[44:47], v15 offset:0
    ds_read_b128 v[48:51], v15 offset:4096
    ds_read_b64_tr_b16 v[56:57], v31 offset:1024
    ds_read_b64_tr_b16 v[58:59], v31 offset:1280
    s_waitcnt lgkmcnt(4)
    v_mfma_f32_32x32x16_bf16 v[60:75], v[52:55], v[36:39], v[60:75]
    s_add_u32 s62, s62, 1
    s_cmp_eq_u32 s62, 10
    s_cselect_b32 s63, 4294966016, 0
    s_cselect_b32 s64, 4294148096, 0
    s_cselect_b32 s62, 0, s62
    s_add_u32 s63, s63, 128
    s_add_u32 s64, s64, 81920
    s_add_u32 m0, s46, 0
    s_nop 0
    buffer_load_dwordx4 v1, s[28:31], s40 offen lds
    s_add_u32 s40, s40, s63
    v_mfma_f32_32x32x16_bf16 v[76:91], v[52:55], v[40:43], v[76:91]
    s_add_u32 m0, s47, 0
    s_nop 0
    buffer_load_dwordx4 v2, s[28:31], s41 offen lds
    s_add_u32 s41, s41, s63
    ds_read_b128 v[36:39], v16 offset:0
    ds_read_b128 v[40:43], v16 offset:4096
    ds_read_b64_tr_b16 v[52:53], v31 offset:2048
    ds_read_b64_tr_b16 v[54:55], v31 offset:2304
    s_waitcnt lgkmcnt(4)
    v_mfma_f32_32x32x16_bf16 v[60:75], v[56:59], v[44:47], v[60:75]
    s_add_u32 m0, s48, 0
    s_nop 0
    buffer_load_dwordx4 v3, s[32:35], s42 offen lds
    s_add_u32 s42, s42, s64
    v_mfma_f32_32x32x16_bf16 v[76:91], v[56:59], v[48:51], v[76:91]
    ds_read_b128 v[44:47], v17 offset:0
    ds_read_b128 v[48:51], v17 offset:4096
    ds_read_b64_tr_b16 v[56:57], v31 offset:3072
    ds_read_b64_tr_b16 v[58:59], v31 offset:3328
    s_waitcnt lgkmcnt(4)
    v_mfma_f32_32x32x16_bf16 v[60:75], v[52:55], v[36:39], v[60:75]
    s_add_u32 m0, s49, 0
    s_nop 0
    buffer_load_dwordx4 v3, s[32:35], s43 offen lds
    s_add_u32 s43, s43, s64
    v_mfma_f32_32x32x16_bf16 v[76:91], v[52:55], v[40:43], v[76:91]
    s_add_u32 m0, s50, 0
    s_nop 0
    buffer_load_dwordx4 v3, s[32:35], s44 offen lds
    s_add_u32 s44, s44, s64
    s_waitcnt lgkmcnt(0)
    v_mfma_f32_32x32x16_bf16 v[60:75], v[56:59], v[44:47], v[60:75]
    s_add_u32 m0, s51, 0
    s_nop 0
    buffer_load_dwordx4 v3, s[32:35], s45 offen lds
    s_add_u32 s45, s45, s64
    v_mfma_f32_32x32x16_bf16 v[76:91], v[56:59], v[48:51], v[76:91]
    s_waitcnt vmcnt(18)
    s_barrier
    ds_read_b128 v[36:39], v18 offset:0
    ds_read_b128 v[40:43], v18 offset:4096
    ds_read_b64_tr_b16 v[52:53], v32 offset:0
    ds_read_b64_tr_b16 v[54:55], v32 offset:256
    ds_read_b128 v[44:47], v19 offset:0
    ds_read_b128 v[48:51], v19 offset:4096
    ds_read_b64_tr_b16 v[56:57], v32 offset:1024
    ds_read_b64_tr_b16 v[58:59], v32 offset:1280
    s_waitcnt lgkmcnt(4)
    v_mfma_f32_32x32x16_bf16 v[60:75], v[52:55], v[36:39], v[60:75]
    s_add_u32 s62, s62, 1
    s_cmp_eq_u32 s62, 10
    s_cselect_b32 s63, 4294966016, 0
    s_cselect_b32 s64, 4294148096, 0
    s_cselect_b32 s62, 0, s62
    s_add_u32 s63, s63, 128
    s_add_u32 s64, s64, 81920
    s_add_u32 m0, s46, 28672
    s_nop 0
    buffer_load_dwordx4 v1, s[28:31], s40 offen lds
    s_add_u32 s40, s40, s63
    v_mfma_f32_32x32x16_bf16 v[76:91], v[52:55], v[40:43], v[76:91]
    s_add_u32 m0, s47, 28672
    s_nop 0
    buffer_load_dwordx4 v2, s[28:31], s41 offen lds
    s_add_u32 s41, s41, s63
    ds_read_b128 v[36:39], v20 offset:0
    ds_read_b128 v[40:43], v20 offset:4096
    ds_read_b64_tr_b16 v[52:53], v32 offset:2048
    ds_read_b64_tr_b16 v[54:55], v32 offset:2304
    s_waitcnt lgkmcnt(4)
    v_mfma_f32_32x32x16_bf16 v[60:75], v[56:59], v[44:47], v[60:75]
    s_add_u32 m0, s48, 28672
    s_nop 0
    buffer_load_dwordx4 v3, s[32:35], s42 offen lds
    s_add_u32 s42, s42, s64
    v_mfma_f32_32x32x16_bf16 v[76:91], v[56:59], v[48:51], v[76:91]
    ds_read_b128 v[44:47], v21 offset:0
    ds_read_b128 v[48:51], v21 offset:4096
    ds_read_b64_tr_b16 v[56:57], v32 offset:3072
    ds_read_b64_tr_b16 v[58:59], v32 offset:3328
    s_waitcnt lgkmcnt(4)
    v_mfma_f32_32x32x16_bf16 v[60:75], v[52:55], v[36:39], v[60:75]
    s_add_u32 m0, s49, 28672
    s_nop 0
    buffer_load_dwordx4 v3, s[32:35], s43 offen lds
    s_add_u32 s43, s43, s64
    v_mfma_f32_32x32x16_bf16 v[76:91], v[52:55], v[40:43], v[76:91]
    s_add_u32 m0, s50, 28672
    s_nop 0
    buffer_load_dwordx4 v3, s[32:35], s44 offen lds
    s_add_u32 s44, s44, s64
    s_waitcnt lgkmcnt(0)
    v_mfma_f32_32x32x16_bf16 v[60:75], v[56:59], v[44:47], v[60:75]
    s_add_u32 m0, s51, 28672
    s_nop 0
    buffer_load_dwordx4 v3, s[32:35], s45 offen lds
    s_add_u32 s45, s45, s64
    v_mfma_f32_32x32x16_bf16 v[76:91], v[56:59], v[48:51], v[76:91]
    s_waitcnt vmcnt(18)
    s_barrier
    ds_read_b128 v[36:39], v22 offset:0
    ds_read_b128 v[40:43], v22 offset:4096
    ds_read_b64_tr_b16 v[52:53], v33 offset:0
    ds_read_b64_tr_b16 v[54:55], v33 offset:256
    ds_read_b128 v[44:47], v23 offset:0
    ds_read_b128 v[48:51], v23 offset:4096
    ds_read_b64_tr_b16 v[56:57], v33 offset:1024
    ds_read_b64_tr_b16 v[58:59], v33 offset:1280
    s_waitcnt lgkmcnt(4)
    v_mfma_f32_32x32x16_bf16 v[60:75], v[52:55], v[36:39], v[60:75]
    s_add_u32 s62, s62, 1
    s_cmp_eq_u32 s62, 10
    s_cselect_b32 s63, 4294966016, 0
    s_cselect_b32 s64, 4294148096, 0
    s_cselect_b32 s62, 0, s62
    s_add_u32 s63, s63, 128
    s_add_u32 s64, s64, 81920
    s_add_u32 m0, s46, 57344
    s_nop 0
    buffer_load_dwordx4 v1, s[28:31], s40 offen lds
    s_add_u32 s40, s40, s63
    v_mfma_f32_32x32x16_bf16 v[76:91], v[52:55], v[40:43], v[76:91]
    s_add_u32 m0, s47, 57344
    s_nop 0
    buffer_load_dwordx4 v2, s[28:31], s41 offen lds
    s_add_u32 s41, s41, s63
    ds_read_b128 v[36:39], v24 offset:0
    ds_read_b128 v[40:43], v24 offset:4096
    ds_read_b64_tr_b16 v[52:53], v33 offset:2048
    ds_read_b64_tr_b16 v[54:55], v33 offset:2304
    s_waitcnt lgkmcnt(4)
    v_mfma_f32_32x32x16_bf16 v[60:75], v[56:59], v[44:47], v[60:75]
    s_add_u32 m0, s48, 57344
    s_nop 0
    buffer_load_dwordx4 v3, s[32:35], s42 offen lds
    s_add_u32 s42, s42, s64
    v_mfma_f32_32x32x16_bf16 v[76:91], v[56:59], v[48:51], v[76:91]
    ds_read_b128 v[44:47], v25 offset:0
    ds_read_b128 v[48:51], v25 offset:4096
    ds_read_b64_tr_b16 v[56:57], v33 offset:3072
    ds_read_b64_tr_b16 v[58:59], v33 offset:3328
    s_waitcnt lgkmcnt(4)
    v_mfma_f32_32x32x16_bf16 v[60:75], v[52:55], v[36:39], v[60:75]
    s_add_u32 m0, s49, 57344
    s_nop 0
    buffer_load_dwordx4 v3, s[32:35], s43 offen lds
    s_add_u32 s43, s43, s64
    v_mfma_f32_32x32x16_bf16 v[76:91], v[52:55], v[40:43], v[76:91]
    s_add_u32 m0, s50, 57344
    s_nop 0
    buffer_load_dwordx4 v3, s[32:35], s44 offen lds
    s_add_u32 s44, s44, s64
    s_waitcnt lgkmcnt(0)
    v_mfma_f32_32x32x16_bf16 v[60:75], v[56:59], v[44:47], v[60:75]
    s_add_u32 m0, s51, 57344
    s_nop 0
    buffer_load_dwordx4 v3, s[32:35], s45 offen lds
    s_add_u32 s45, s45, s64
    v_mfma_f32_32x32x16_bf16 v[76:91], v[56:59], v[48:51], v[76:91]
    s_waitcnt vmcnt(18)
    s_barrier
    ds_read_b128 v[36:39], v26 offset:0
    ds_read_b128 v[40:43], v26 offset:4096
    ds_read_b64_tr_b16 v[52:53], v34 offset:0
    ds_read_b64_tr_b16 v[54:55], v34 offset:256
    ds_read_b128 v[44:47], v27 offset:0
    ds_read_b128 v[48:51], v27 offset:4096
    ds_read_b64_tr_b16 v[56:57], v34 offset:1024
    ds_read_b64_tr_b16 v[58:59], v34 offset:1280
    s_waitcnt lgkmcnt(4)
    v_mfma_f32_32x32x16_bf16 v[60:75], v[52:55], v[36:39], v[60:75]
    s_add_u32 s62, s62, 1
    s_cmp_eq_u32 s62, 10
    s_cselect_b32 s63, 4294966016, 0
    s_cselect_b32 s64, 4294148096, 0
    s_cselect_b32 s62, 0, s62
    s_add_u32 s63, s63, 128
    s_add_u32 s64, s64, 81920
    s_add_u32 m0, s46, 86016
    s_nop 0
    buffer_load_dwordx4 v1, s[28:31], s40 offen lds
    s_add_u32 s40, s40, s63
    v_mfma_f32_32x32x16_bf16 v[76:91], v[52:55], v[40:43], v[76:91]
    s_add_u32 m0, s47, 86016
    s_nop 0
    buffer_load_dwordx4 v2, s[28:31], s41 offen lds
    s_add_u32 s41, s41, s63
    ds_read_b128 v[36:39], v28 offset:0
    ds_read_b128 v[40:43], v28 offset:4096
    ds_read_b64_tr_b16 v[52:53], v34 offset:2048
    ds_read_b64_tr_b16 v[54:55], v34 offset:2304
    s_waitcnt lgkmcnt(4)
    v_mfma_f32_32x32x16_bf16 v[60:75], v[56:59], v[44:47], v[60:75]
    s_add_u32 m0, s48, 86016
    s_nop 0
    buffer_load_dwordx4 v3, s[32:35], s42 offen lds
    s_add_u32 s42, s42, s64
    v_mfma_f32_32x32x16_bf16 v[76:91], v[56:59], v[48:51], v[76:91]
    ds_read_b128 v[44:47], v29 offset:0
    ds_read_b128 v[48:51], v29 offset:4096
    ds_read_b64_tr_b16 v[56:57], v34 offset:3072
    ds_read_b64_tr_b16 v[58:59], v34 offset:3328
    s_waitcnt lgkmcnt(4)
    v_mfma_f32_32x32x16_bf16 v[60:75], v[52:55], v[36:39], v[60:75]
    s_add_u32 m0, s49, 86016
    s_nop 0
    buffer_load_dwordx4 v3, s[32:35], s43 offen lds
    s_add_u32 s43, s43, s64
    v_mfma_f32_32x32x16_bf16 v[76:91], v[52:55], v[40:43], v[76:91]
    s_add_u32 m0, s50, 86016
    s_nop 0
    buffer_load_dwordx4 v3, s[32:35], s44 offen lds
    s_add_u32 s44, s44, s64
    s_waitcnt lgkmcnt(0)
    v_mfma_f32_32x32x16_bf16 v[60:75], v[56:59], v[44:47], v[60:75]
    s_add_u32 m0, s51, 86016
    s_nop 0
    buffer_load_dwordx4 v3, s[32:35], s45 offen lds
    s_add_u32 s45, s45, s64
    v_mfma_f32_32x32x16_bf16 v[76:91], v[56:59], v[48:51], v[76:91]
    s_waitcnt vmcnt(18)
    s_barrier
    ds_read_b128 v[36:39], v10 offset:0
    ds_read_b128 v[40:43], v10 offset:4096
    ds_read_b64_tr_b16 v[52:53], v30 offset:0
    ds_read_b64_tr_b16 v[54:55], v30 offset:256
    ds_read_b128 v[44:47], v11 offset:0
    ds_read_b128 v[48:51], v11 offset:4096
    ds_read_b64_tr_b16 v[56:57], v30 offset:1024
    ds_read_b64_tr_b16 v[58:59], v30 offset:1280
    s_waitcnt lgkmcnt(4)
    v_mfma_f32_32x32x16_bf16 v[60:75], v[52:55], v[36:39], v[60:75]
    s_add_u32 s62, s62, 1
    s_cmp_eq_u32 s62, 10
    s_cselect_b32 s63, 4294966016, 0
    s_cselect_b32 s64, 4294148096, 0
    s_cselect_b32 s62, 0, s62
    s_add_u32 s63, s63, 128
    s_add_u32 s64, s64, 81920
    s_add_u32 m0, s46, 114688
    s_nop 0
    buffer_load_dwordx4 v1, s[28:31], s40 offen lds
    s_add_u32 s40, s40, s63
    v_mfma_f32_32x32x16_bf16 v[76:91], v[52:55], v[40:43], v[76:91]
    s_add_u32 m0, s47, 114688
    s_nop 0
    buffer_load_dwordx4 v2, s[28:31], s41 offen lds
    s_add_u32 s41, s41, s63
    ds_read_b128 v[36:39], v12 offset:0
    ds_read_b128 v[40:43], v12 offset:4096
    ds_read_b64_tr_b16 v[52:53], v30 offset:2048
    ds_read_b64_tr_b16 v[54:55], v30 offset:2304
    s_waitcnt lgkmcnt(4)
    v_mfma_f32_32x32x16_bf16 v[60:75], v[56:59], v[44:47], v[60:75]
    s_add_u32 m0, s48, 114688
    s_nop 0
    buffer_load_dwordx4 v3, s[32:35], s42 offen lds
    s_add_u32 s42, s42, s64
    v_mfma_f32_32x32x16_bf16 v[76:91], v[56:59], v[48:51], v[76:91]
    ds_read_b128 v[44:47], v13 offset:0
    ds_read_b128 v[48:51], v13 offset:4096
    ds_read_b64_tr_b16 v[56:57], v30 offset:3072
    ds_read_b64_tr_b16 v[58:59], v30 offset:3328
    s_waitcnt lgkmcnt(4)
    v_mfma_f32_32x32x16_bf16 v[60:75], v[52:55], v[36:39], v[60:75]
    s_add_u32 m0, s49, 114688
    s_nop 0
    buffer_load_dwordx4 v3, s[32:35], s43 offen lds
    s_add_u32 s43, s43, s64
    v_mfma_f32_32x32x16_bf16 v[76:91], v[52:55], v[40:43], v[76:91]
    s_add_u32 m0, s50, 114688
    s_nop 0
    buffer_load_dwordx4 v3, s[32:35], s44 offen lds
    s_add_u32 s44, s44, s64
    s_waitcnt lgkmcnt(0)
    v_mfma_f32_32x32x16_bf16 v[60:75], v[56:59], v[44:47], v[60:75]
    s_add_u32 m0, s51, 114688
    s_nop 0
    buffer_load_dwordx4 v3, s[32:35], s45 offen lds
    s_add_u32 s45, s45, s64
    v_mfma_f32_32x32x16_bf16 v[76:91], v[56:59], v[48:51], v[76:91]
    s_waitcnt vmcnt(18)
    s_barrier
    ds_read_b128 v[36:39], v14 offset:0
    ds_read_b128 v[40:43], v14 offset:4096
    ds_read_b64_tr_b16 v[52:53], v31 offset:0
    ds_read_b64_tr_b16 v[54:55], v31 offset:256
    ds_read_b128 v[44:47], v15 offset:0
    ds_read_b128 v[48:51], v15 offset:4096
    ds_read_b64_tr_b16 v[56:57], v31 offset:1024
    ds_read_b64_tr_b16 v[58:59], v31 offset:1280
    s_waitcnt lgkmcnt(4)
    v_mfma_f32_32x32x16_bf16 v[60:75], v[52:55], v[36:39], v[60:75]
    v_mfma_f32_32x32x16_bf16 v[76:91], v[52:55], v[40:43], v[76:91]
    ds_read_b128 v[36:39], v16 offset:0
    ds_read_b128 v[40:43], v16 offset:4096
    ds_read_b64_tr_b16 v[52:53], v31 offset:2048
    ds_read_b64_tr_b16 v[54:55], v31 offset:2304
    s_waitcnt lgkmcnt(4)
    v_mfma_f32_32x32x16_bf16 v[60:75], v[56:59], v[44:47], v[60:75]
    v_mfma_f32_32x32x16_bf16 v[76:91], v[56:59], v[48:51], v[76:91]
    ds_read_b128 v[44:47], v17 offset:0
    ds_read_b128 v[48:51], v17 offset:4096
    ds_read_b64_tr_b16 v[56:57], v31 offset:3072
    ds_read_b64_tr_b16 v[58:59], v31 offset:3328
    s_waitcnt lgkmcnt(4)
    v_mfma_f32_32x32x16_bf16 v[60:75], v[52:55], v[36:39], v[60:75]
    v_mfma_f32_32x32x16_bf16 v[76:91], v[52:55], v[40:43], v[76:91]
    s_waitcnt lgkmcnt(0)
    v_mfma_f32_32x32x16_bf16 v[60:75], v[56:59], v[44:47], v[60:75]
    v_mfma_f32_32x32x16_bf16 v[76:91], v[56:59], v[48:51], v[76:91]
    s_waitcnt vmcnt(12)
    s_barrier
    ds_read_b128 v[36:39], v18 offset:0
    ds_read_b128 v[40:43], v18 offset:4096
    ds_read_b64_tr_b16 v[52:53], v32 offset:0
    ds_read_b64_tr_b16 v[54:55], v32 offset:256
    ds_read_b128 v[44:47], v19 offset:0
    ds_read_b128 v[48:51], v19 offset:4096
    ds_read_b64_tr_b16 v[56:57], v32 offset:1024
    ds_read_b64_tr_b16 v[58:59], v32 offset:1280
    s_waitcnt lgkmcnt(4)
    v_mfma_f32_32x32x16_bf16 v[60:75], v[52:55], v[36:39], v[60:75]
    v_mfma_f32_32x32x16_bf16 v[76:91], v[52:55], v[40:43], v[76:91]
    ds_read_b128 v[36:39], v20 offset:0
    ds_read_b128 v[40:43], v20 offset:4096
    ds_read_b64_tr_b16 v[52:53], v32 offset:2048
    ds_read_b64_tr_b16 v[54:55], v32 offset:2304
    s_waitcnt lgkmcnt(4)
    v_mfma_f32_32x32x16_bf16 v[60:75], v[56:59], v[44:47], v[60:75]
    v_mfma_f32_32x32x16_bf16 v[76:91], v[56:59], v[48:51], v[76:91]
    ds_read_b128 v[44:47], v21 offset:0
    ds_read_b128 v[48:51], v21 offset:4096
    ds_read_b64_tr_b16 v[56:57], v32 offset:3072
    ds_read_b64_tr_b16 v[58:59], v32 offset:3328
    s_waitcnt lgkmcnt(4)
    v_mfma_f32_32x32x16_bf16 v[60:75], v[52:55], v[36:39], v[60:75]
    v_mfma_f32_32x32x16_bf16 v[76:91], v[52:55], v[40:43], v[76:91]
    s_waitcnt lgkmcnt(0)
    v_mfma_f32_32x32x16_bf16 v[60:75], v[56:59], v[44:47], v[60:75]
    v_mfma_f32_32x32x16_bf16 v[76:91], v[56:59], v[48:51], v[76:91]
    s_waitcnt vmcnt(6)
    s_barrier
    ds_read_b128 v[36:39], v22 offset:0
    ds_read_b128 v[40:43], v22 offset:4096
    ds_read_b64_tr_b16 v[52:53], v33 offset:0
    ds_read_b64_tr_b16 v[54:55], v33 offset:256
    ds_read_b128 v[44:47], v23 offset:0
    ds_read_b128 v[48:51], v23 offset:4096
    ds_read_b64_tr_b16 v[56:57], v33 offset:1024
    ds_read_b64_tr_b16 v[58:59], v33 offset:1280
    s_waitcnt lgkmcnt(4)
    v_mfma_f32_32x32x16_bf16 v[60:75], v[52:55], v[36:39], v[60:75]
    v_mfma_f32_32x32x16_bf16 v[76:91], v[52:55], v[40:43], v[76:91]
    ds_read_b128 v[36:39], v24 offset:0
    ds_read_b128 v[40:43], v24 offset:4096
    ds_read_b64_tr_b16 v[52:53], v33 offset:2048
    ds_read_b64_tr_b16 v[54:55], v33 offset:2304
    s_waitcnt lgkmcnt(4)
    v_mfma_f32_32x32x16_bf16 v[60:75], v[56:59], v[44:47], v[60:75]
    v_mfma_f32_32x32x16_bf16 v[76:91], v[56:59], v[48:51], v[76:91]
    ds_read_b128 v[44:47], v25 offset:0
    ds_read_b128 v[48:51], v25 offset:4096
    ds_read_b64_tr_b16 v[56:57], v33 offset:3072
    ds_read_b64_tr_b16 v[58:59], v33 offset:3328
    s_waitcnt lgkmcnt(4)
    v_mfma_f32_32x32x16_bf16 v[60:75], v[52:55], v[36:39], v[60:75]
    v_mfma_f32_32x32x16_bf16 v[76:91], v[52:55], v[40:43], v[76:91]
    s_waitcnt lgkmcnt(0)
    v_mfma_f32_32x32x16_bf16 v[60:75], v[56:59], v[44:47], v[60:75]
    v_mfma_f32_32x32x16_bf16 v[76:91], v[56:59], v[48:51], v[76:91]
    s_waitcnt vmcnt(0)
    s_barrier
    ds_read_b128 v[36:39], v26 offset:0
    ds_read_b128 v[40:43], v26 offset:4096
    ds_read_b64_tr_b16 v[52:53], v34 offset:0
    ds_read_b64_tr_b16 v[54:55], v34 offset:256
    ds_read_b128 v[44:47], v27 offset:0
    ds_read_b128 v[48:51], v27 offset:4096
    ds_read_b64_tr_b16 v[56:57], v34 offset:1024
    ds_read_b64_tr_b16 v[58:59], v34 offset:1280
    s_waitcnt lgkmcnt(4)
    v_mfma_f32_32x32x16_bf16 v[60:75], v[52:55], v[36:39], v[60:75]
    v_mfma_f32_32x32x16_bf16 v[76:91], v[52:55], v[40:43], v[76:91]
    ds_read_b128 v[36:39], v28 offset:0
    ds_read_b128 v[40:43], v28 offset:4096
    ds_read_b64_tr_b16 v[52:53], v34 offset:2048
    ds_read_b64_tr_b16 v[54:55], v34 offset:2304
    s_waitcnt lgkmcnt(4)
    v_mfma_f32_32x32x16_bf16 v[60:75], v[56:59], v[44:47], v[60:75]
    v_mfma_f32_32x32x16_bf16 v[76:91], v[56:59], v[48:51], v[76:91]
    ds_read_b128 v[44:47], v29 offset:0
    ds_read_b128 v[48:51], v29 offset:4096
    ds_read_b64_tr_b16 v[56:57], v34 offset:3072
    ds_read_b64_tr_b16 v[58:59], v34 offset:3328
    s_waitcnt lgkmcnt(4)
    v_mfma_f32_32x32x16_bf16 v[60:75], v[52:55], v[36:39], v[60:75]
    v_mfma_f32_32x32x16_bf16 v[76:91], v[52:55], v[40:43], v[76:91]
    s_waitcnt lgkmcnt(0)
    v_mfma_f32_32x32x16_bf16 v[60:75], v[56:59], v[44:47], v[60:75]
    v_mfma_f32_32x32x16_bf16 v[76:91], v[56:59], v[48:51], v[76:91]
    s_nop 15
    v_and_b32 v4, 31, v0
    v_mul_u32_u24 v4, 2560, v4
    v_lshrrev_b32 v5, 5, v0
    v_lshl_add_u32 v4, v5, 3, v4
    s_mul_i32 s52, s23, 163840
    s_mul_i32 s53, s22, 1280
    s_add_u32 s52, s52, s53
    s_mul_i32 s53, s24, 320
    s_add_u32 s52, s52, s53
    s_lshl_b32 s53, s55, 6
    s_add_u32 s52, s52, s53
    s_add_u32 s53, s52, 81920
    v_cvt_pk_bf16_f32 v92, v60, v61
    v_cvt_pk_bf16_f32 v93, v62, v63
    buffer_store_dwordx2 v[92:93], v4, s[36:39], s52 offen offset:0
    v_cvt_pk_bf16_f32 v94, v64, v65
    v_cvt_pk_bf16_f32 v95, v66, v67
    buffer_store_dwordx2 v[94:95], v4, s[36:39], s52 offen offset:16
    v_cvt_pk_bf16_f32 v96, v68, v69
    v_cvt_pk_bf16_f32 v97, v70, v71
    buffer_store_dwordx2 v[96:97], v4, s[36:39], s52 offen offset:32
    v_cvt_pk_bf16_f32 v98, v72, v73
    v_cvt_pk_bf16_f32 v99, v74, v75
    buffer_store_dwordx2 v[98:99], v4, s[36:39], s52 offen offset:48
    v_cvt_pk_bf16_f32 v92, v76, v77
    v_cvt_pk_bf16_f32 v93, v78, v79
    buffer_store_dwordx2 v[92:93], v4, s[36:39], s53 offen offset:0
    v_cvt_pk_bf16_f32 v94, v80, v81
    v_cvt_pk_bf16_f32 v95, v82, v83
    buffer_store_dwordx2 v[94:95], v4, s[36:39], s53 offen offset:16
    v_cvt_pk_bf16_f32 v96, v84, v85
    v_cvt_pk_bf16_f32 v97, v86, v87
    buffer_store_dwordx2 v[96:97], v4, s[36:39], s53 offen offset:32
    v_cvt_pk_bf16_f32 v98, v88, v89
    v_cvt_pk_bf16_f32 v99, v90, v91
    buffer_store_dwordx2 v[98:99], v4, s[36:39], s53 offen offset:48
out_end:
    s_endpgm
.section .rodata,"a"
.p2align 6
.amdhsa_kernel qkv_kernel
  .amdhsa_next_free_vgpr 148
  .amdhsa_next_free_sgpr 66
  .amdhsa_accum_offset 148
  .amdhsa_group_segment_fixed_size 0
  .amdhsa_kernarg_size 72
  .amdhsa_user_sgpr_count 2
  .amdhsa_user_sgpr_kernarg_segment_ptr 1
  .amdhsa_system_sgpr_workgroup_id_x 1
.end_amdhsa_kernel
.amdhsa_kernel att_kernel
  .amdhsa_next_free_vgpr 172
  .amdhsa_next_free_sgpr 80
  .amdhsa_accum_offset 172
  .amdhsa_group_segment_fixed_size 0
  .amdhsa_kernarg_size 72
  .amdhsa_user_sgpr_count 2
  .amdhsa_user_sgpr_kernarg_segment_ptr 1
  .amdhsa_system_sgpr_workgroup_id_x 1
.end_amdhsa_kernel
.amdhsa_kernel out_kernel
  .amdhsa_next_free_vgpr 116
  .amdhsa_next_free_sgpr 66
  .amdhsa_accum_offset 116
  .amdhsa_group_segment_fixed_size 0
  .amdhsa_kernarg_size 72
  .amdhsa_user_sgpr_count 2
  .amdhsa_user_sgpr_kernarg_segment_ptr 1
  .amdhsa_system_sgpr_workgroup_id_x 1
.end_amdhsa_kernel
```
